```python
import torch

def _softmax(x, axis=-1):
    return torch.softmax(x, dim=axis)
def _gelu(x):
    return torch.nn.functional.gelu(x, approximate="tanh")
def _silu(x):
    return torch.nn.functional.silu(x)
def _sigmoid(x):
    return torch.sigmoid(x)
def _layernorm(x, axis=-1, eps=1e-5):
    m = x.mean(dim=axis, keepdim=True)
    v = x.var(dim=axis, keepdim=True, unbiased=False)
    return (x - m) / torch.sqrt(v + eps)
def _scatter_add(tgt, idx, src, axis=0):
    return tgt.clone().index_add_(axis, idx, src)
def _segment_sum(src, seg, n):
    out = torch.zeros((n,) + src.shape[1:], dtype=src.dtype)
    return out.index_add_(0, seg, src)
def _pad(x, pw):
    flat = tuple(v for pair in reversed(pw) for v in pair)
    return torch.nn.functional.pad(x, flat)

kernel_name = 'standalone__edge_featured_mpnn_gatedgcn__graph'

def setup_inputs():

    _w = (lambda a: (lambda t: t.to(torch.bfloat16) if t.is_floating_point() else t)(torch.as_tensor(a)))
    N, deg, D, De = 25000, 16, 128, max(0, 1)
    E = N * deg
    return {
        "x": _w((lambda *s: torch.randn(*s, dtype=torch.bfloat16) * 0.4)(N, D)),
        "e_attr": _w((lambda *s: torch.randn(*s, dtype=torch.bfloat16) * 0.8)(E, De)),
        "src": _w((lambda lo, hi, *s: torch.randint(lo, hi, s))(0, N, E).to(torch.int64)),
        "dst": _w((lambda lo, hi, *s: torch.randint(lo, hi, s))(0, N, E).to(torch.int64)),
        "w_a": _w((lambda *s: torch.randn(*s, dtype=torch.bfloat16) * 0.4)(D, D)),
        "w_b": _w((lambda *s: torch.randn(*s, dtype=torch.bfloat16) * 0.4)(D, D)),
        "w_c": _w((lambda *s: torch.randn(*s, dtype=torch.bfloat16) * 0.8)(De, D)),
        "w_u": _w((lambda *s: torch.randn(*s, dtype=torch.bfloat16) * 0.05)(D, D)),
        "w_v": _w((lambda *s: torch.randn(*s, dtype=torch.bfloat16) * 0.05)(D, D)),
    }

def reference(x, e_attr, src, dst, w_a, w_b, w_c, w_u, w_v):
    N, D = x.shape
    hv = x @ w_v
    g = x[dst] @ w_a + x[src] @ w_b + e_attr @ w_c
    eta = _sigmoid(g)
    denom = _segment_sum(eta, dst, N) + 1e-6
    eta_n = eta / denom[dst]
    agg = _segment_sum(eta_n * hv[src], dst, N)
    z = x @ w_u + agg
    relu_z = torch.where(z > 0, z, 0 * z)
    return x + relu_z
```

```asm
; @launch grid=(256,1,1) block=(1024,1,1) lds=144256
.amdgcn_target "amdgcn-amd-amdhsa--gfx950"
.text
.globl standalone__edge_featured_mpnn_gatedgcn__graph_kernel
.p2align 8
.type standalone__edge_featured_mpnn_gatedgcn__graph_kernel,@function
standalone__edge_featured_mpnn_gatedgcn__graph_kernel:
    s_cmp_ge_u32 s2, 256
    s_cbranch_scc1 L_exit
    s_load_dwordx16 s[4:19], s[0:1], 0
    s_load_dwordx8 s[20:27], s[0:1], 64
    s_getpc_b64 s[70:71]
    v_lshlrev_b32 v3, 6, v0
    s_movk_i32 s74, 181
    v_cmpx_gt_u32 vcc, s74, v0
    global_load_dword v119, v3, s[70:71]
    s_mov_b64 exec, -1
    v_lshrrev_b32 v1, 6, v0
    v_and_b32 v2, 63, v0
    v_readfirstlane_b32 s64, v1
    v_lshlrev_b32 v9, 2, v0
    v_mov_b32 v13, 0
    s_movk_i32 s74, 608
    v_cmpx_gt_u32 vcc, s74, v0
    ds_write_b32 v9, v13
    s_mov_b64 exec, -1
    s_cmp_lt_u32 s64, 9
    s_cbranch_scc1 L_noprio
    s_setprio 3
L_noprio:
    s_mov_b32 s65, 0x8000
    s_mov_b32 s66, 0x07060302
    s_mov_b32 s68, 0xbfb8aa3b
    s_mov_b32 s69, 0x3800000
    s_mov_b32 s72, 0x358637bd
    s_mov_b32 s73, 0x358637bd
    s_bfe_u32 s67, s2, 0x10002
    s_lshl_b32 s67, s67, 1
    s_lshr_b32 s78, s2, 3
    s_and_b32 s74, s2, 3
    s_lshl_b32 s74, s74, 5
    s_add_u32 s78, s78, s74
    s_mul_i32 s79, s78, 196
    v_mov_b32 v15, 1
    v_and_b32 v1, 7, v2
    v_lshlrev_b32 v14, 3, v1
    v_subrev_u32 v4, 576, v0
    v_lshlrev_b32 v3, 4, v4
    v_lshlrev_b32 v5, 3, v4
    s_mul_i32 s76, s2, 6256
    s_mul_i32 s75, s2, 3128
    v_lshrrev_b32 v12, 3, v2
    v_lshrrev_b32 v6, 2, v2
    v_and_b32 v6, 4, v6
    v_xor_b32 v6, v6, v1
    v_lshlrev_b32 v6, 4, v6
    v_lshl_add_u32 v12, v12, 8, v6
    s_waitcnt lgkmcnt(0)
    s_mov_b32 s60, s24
    s_and_b32 s61, s25, 0xffff
    s_mov_b32 s62, 256
    s_mov_b32 s63, 0x20000
    s_cmp_eq_u32 s64, 8
    s_cbranch_scc0 L_notag
    s_cmp_eq_u32 s2, 0
    s_cbranch_scc0 L_notag
    s_memrealtime s[70:71]
    s_waitcnt lgkmcnt(0)
    s_lshl_b32 s74, s70, 22
    s_lshr_b64 s[70:71], s[70:71], 10
    s_or_b32 s77, s70, 0x80000000
    v_mov_b32 v6, s74
    v_mov_b32 v7, s77
    s_mov_b64 exec, 1
    buffer_store_dwordx2 v[6:7], v13, s[60:63], 0 offen sc1
    s_mov_b64 exec, -1
L_notag:
    s_mov_b32 s36, s10
    s_and_b32 s37, s11, 0xffff
    s_mov_b32 s38, 1600000
    s_mov_b32 s39, 0x20000
    s_mov_b32 s40, s8
    s_and_b32 s41, s9, 0xffff
    s_mov_b32 s42, 1600000
    s_mov_b32 s43, 0x20000
    s_mov_b32 s44, s6
    s_and_b32 s45, s7, 0xffff
    s_mov_b32 s46, 800000
    s_mov_b32 s47, 0x20000
    s_cmp_lt_u32 s64, 9
    s_cbranch_scc1 L_noedge
    buffer_load_dwordx4 v[16:19], v3, s[36:39], s76 offen
    buffer_load_dwordx4 v[20:23], v3, s[40:43], s76 offen
    buffer_load_dwordx2 v[24:25], v5, s[44:47], s75 offen
L_noedge:
    s_barrier
    s_cmp_lt_u32 s64, 8
    s_cbranch_scc0 L_now
    s_bitcmp1_b32 s64, 2
    s_cselect_b32 s74, s12, s14
    s_cselect_b32 s75, s13, s15
    s_cselect_b32 s76, s18, s20
    s_cselect_b32 s77, s19, s21
    s_bitcmp1_b32 s64, 1
    s_cselect_b32 s32, s76, s74
    s_cselect_b32 s33, s77, s75
    s_and_b32 s33, s33, 0xffff
    s_mov_b32 s34, 32768
    s_mov_b32 s35, 0x20000
    s_and_b32 s74, s64, 1
    s_lshl_b32 s74, s74, 14
    s_lshl_b32 s75, s67, 6
    s_add_u32 s74, s74, s75
    s_lshl_b32 s76, s64, 13
    s_add_u32 m0, s76, 64128
    s_add_u32 s77, s74, 0
    buffer_load_dwordx4 v12, s[32:35], s77 offen lds
    s_add_u32 m0, s76, 65152
    s_add_u32 s77, s74, 2048
    buffer_load_dwordx4 v12, s[32:35], s77 offen lds
    s_add_u32 m0, s76, 66176
    s_add_u32 s77, s74, 4096
    buffer_load_dwordx4 v12, s[32:35], s77 offen lds
    s_add_u32 m0, s76, 67200
    s_add_u32 s77, s74, 6144
    buffer_load_dwordx4 v12, s[32:35], s77 offen lds
    s_add_u32 m0, s76, 68224
    s_add_u32 s77, s74, 8192
    buffer_load_dwordx4 v12, s[32:35], s77 offen lds
    s_add_u32 m0, s76, 69248
    s_add_u32 s77, s74, 10240
    buffer_load_dwordx4 v12, s[32:35], s77 offen lds
    s_add_u32 m0, s76, 70272
    s_add_u32 s77, s74, 12288
    buffer_load_dwordx4 v12, s[32:35], s77 offen lds
    s_add_u32 m0, s76, 71296
    s_add_u32 s77, s74, 14336
    buffer_load_dwordx4 v12, s[32:35], s77 offen lds
    s_mov_b64 exec, 1
    ds_add_u32 v13, v15 offset:2372
    s_mov_b64 exec, -1
L_now:
    s_mov_b32 s32, s16
    s_and_b32 s33, s17, 0xffff
    s_mov_b32 s34, 256
    s_mov_b32 s35, 0x20000
    s_lshl_b32 s75, s67, 6
    buffer_load_dwordx2 v[124:125], v14, s[32:35], s75 offen
    buffer_load_dwordx2 v[126:127], v14, s[32:35], s75 offen offset:64
    s_mov_b32 s48, s4
    s_and_b32 s49, s5, 0xffff
    s_mov_b32 s50, 6400000
    s_mov_b32 s51, 0x20000
    s_mov_b32 s28, s26
    s_and_b32 s29, s27, 0xffff
    s_mov_b32 s30, 16326656
    s_mov_b32 s31, 0x20000
    s_mov_b32 s56, s22
    s_and_b32 s57, s23, 0xffff
    s_mov_b32 s58, 6400000
    s_mov_b32 s59, 0x20000
    s_mul_i32 s74, s67, 3212288
    s_add_u32 s52, s26, s74
    s_addc_u32 s53, s27, 0
    s_and_b32 s53, s53, 0xffff
    s_mov_b32 s54, 6424576
    s_mov_b32 s55, 0x20000
    s_cmp_lt_u32 s64, 9
    s_cbranch_scc1 L_gemm
    s_cmp_eq_u32 s2, 255
    s_movk_i32 s76, 391
    s_cselect_b32 s76, 295, s76
    s_mov_b32 s75, 85599
    s_movk_i32 s77, 196
    s_waitcnt vmcnt(2)
    s_cmp_eq_u32 s64, 15
    s_cbranch_scc0 L_notl
    buffer_load_dwordx2 v[48:49], v13, s[60:63], 0 offen sc1
L_notl:
    v_mul_u32_u24 v28, s75, v16
    v_lshrrev_b32 v28, 24, v28
    v_mul_u32_u24 v3, s77, v28
    v_sub_u32 v3, v16, v3
    v_lshlrev_b32 v3, 2, v3
    v_lshl_or_b32 v36, v20, 16, v3
    v_lshlrev_b32 v28, 2, v28
    v_lshlrev_b32 v37, 16, v24
    v_mul_u32_u24 v29, s75, v17
    v_lshrrev_b32 v29, 24, v29
    v_mul_u32_u24 v3, s77, v29
    v_sub_u32 v3, v17, v3
    v_lshlrev_b32 v3, 2, v3
    v_lshl_or_b32 v38, v21, 16, v3
    v_lshlrev_b32 v29, 2, v29
    v_and_b32 v39, 0xffff0000, v24
    v_mul_u32_u24 v30, s75, v18
    v_lshrrev_b32 v30, 24, v30
    v_mul_u32_u24 v3, s77, v30
    v_sub_u32 v3, v18, v3
    v_lshlrev_b32 v3, 2, v3
    v_lshl_or_b32 v40, v22, 16, v3
    v_lshlrev_b32 v30, 2, v30
    v_lshlrev_b32 v41, 16, v25
    v_mul_u32_u24 v31, s75, v19
    v_lshrrev_b32 v31, 24, v31
    v_mul_u32_u24 v3, s77, v31
    v_sub_u32 v3, v19, v3
    v_lshlrev_b32 v3, 2, v3
    v_lshl_or_b32 v42, v23, 16, v3
    v_lshlrev_b32 v31, 2, v31
    v_and_b32 v43, 0xffff0000, v25
    v_cmpx_gt_u32 vcc, s76, v4
    ds_add_rtn_u32 v32, v28, v15 offset:0
    ds_add_rtn_u32 v33, v29, v15 offset:0
    ds_add_rtn_u32 v34, v30, v15 offset:0
    ds_add_rtn_u32 v35, v31, v15 offset:0
    s_mov_b64 exec, -1
    v_lshlrev_b32 v8, 3, v2
    s_cmp_eq_u32 s64, 14
    s_cbranch_scc0 L_noxd
    v_lshrrev_b32 v46, 4, v2
    v_lshlrev_b32 v44, 2, v46
    v_and_b32 v45, 15, v2
    v_xor_b32 v44, v44, v45
    v_lshlrev_b32 v44, 4, v44
    v_lshl_add_u32 v46, v46, 8, v44
    s_add_u32 s74, s79, 144
    s_lshl_b32 s74, s74, 8
    s_mov_b32 m0, 43328
    s_nop 0
    buffer_load_dwordx4 v46, s[48:51], s74 offen offset:0 lds
    s_mov_b32 m0, 43344
    s_nop 0
    buffer_load_dwordx4 v46, s[48:51], s74 offen offset:1024 lds
    s_mov_b32 m0, 43360
    s_nop 0
    buffer_load_dwordx4 v46, s[48:51], s74 offen offset:2048 lds
    s_mov_b32 m0, 43376
    s_nop 0
    buffer_load_dwordx4 v46, s[48:51], s74 offen offset:3072 lds
    s_add_u32 s74, s74, 4096
    s_mov_b32 m0, 47488
    s_nop 0
    buffer_load_dwordx4 v46, s[48:51], s74 offen offset:0 lds
    s_mov_b32 m0, 47504
    s_nop 0
    buffer_load_dwordx4 v46, s[48:51], s74 offen offset:1024 lds
    s_mov_b32 m0, 47520
    s_nop 0
    buffer_load_dwordx4 v46, s[48:51], s74 offen offset:2048 lds
    s_mov_b32 m0, 47536
    s_nop 0
    buffer_load_dwordx4 v46, s[48:51], s74 offen offset:3072 lds
    s_add_u32 s74, s74, 4096
    s_mov_b32 m0, 51648
    s_nop 0
    buffer_load_dwordx4 v46, s[48:51], s74 offen offset:0 lds
    s_mov_b32 m0, 51664
    s_nop 0
    buffer_load_dwordx4 v46, s[48:51], s74 offen offset:1024 lds
    s_mov_b32 m0, 51680
    s_nop 0
    buffer_load_dwordx4 v46, s[48:51], s74 offen offset:2048 lds
    s_mov_b32 m0, 51696
    s_nop 0
    buffer_load_dwordx4 v46, s[48:51], s74 offen offset:3072 lds
    s_add_u32 s74, s74, 4096
    s_mov_b32 m0, 55808
    s_nop 0
    buffer_load_dwordx4 v46, s[48:51], s74 offen offset:0 lds
L_noxd:
    s_waitcnt lgkmcnt(0)
    s_mov_b64 exec, 1
    ds_add_u32 v13, v15 offset:2312
    s_mov_b64 exec, -1
    s_mov_b32 s87, 4194304
L_sb1:
    ds_read_b32 v3, v13 offset:2312
    s_waitcnt lgkmcnt(0)
    v_readfirstlane_b32 s74, v3
    s_cmp_ge_u32 s74, 7
    s_cbranch_scc1 L_sb1_ok
    s_sub_u32 s87, s87, 1
    s_cbranch_scc0 L_sb1
L_sb1_ok:
    s_cmp_eq_u32 s64, 15
    s_cbranch_scc0 L_notl2
    buffer_load_dwordx2 v[70:71], v13, s[60:63], 0 offen sc1
L_notl2:
    ds_read_b64 v[6:7], v8 offset:0
    s_waitcnt lgkmcnt(0)
    v_add_u32 v11, v6, v7
    s_nop 1
    v_add_u32_dpp v11, v11, v11 row_shr:1 row_mask:0xf bank_mask:0xf bound_ctrl:0
    s_nop 1
    v_add_u32_dpp v11, v11, v11 row_shr:2 row_mask:0xf bank_mask:0xf bound_ctrl:0
    s_nop 1
    v_add_u32_dpp v11, v11, v11 row_shr:4 row_mask:0xf bank_mask:0xf bound_ctrl:0
    s_nop 1
    v_add_u32_dpp v11, v11, v11 row_shr:8 row_mask:0xf bank_mask:0xf bound_ctrl:0
    s_nop 1
    v_add_u32_dpp v11, v11, v11 row_bcast:15 row_mask:0xa bank_mask:0xf
    s_nop 1
    v_add_u32_dpp v11, v11, v11 row_bcast:31 row_mask:0xc bank_mask:0xf
    v_sub_u32 v11, v11, v7
    v_sub_u32 v10, v11, v6
    ds_write_b64 v8, v[10:11] offset:512
    ds_read_b32 v16, v28 offset:512
    ds_read_b32 v17, v29 offset:512
    ds_read_b32 v18, v30 offset:512
    ds_read_b32 v19, v31 offset:512
    v_lshl_or_b32 v10, v6, 11, v10
    v_lshl_or_b32 v11, v7, 11, v11
    v_mov_b32 v3, 129664
    s_waitcnt lgkmcnt(0)
    v_cmpx_gt_u32 vcc, s76, v4
    v_add_u32 v16, v16, v32
    v_lshl_add_u32 v16, v16, 3, v3
    ds_write_b64 v16, v[36:37]
    v_add_u32 v17, v17, v33
    v_lshl_add_u32 v17, v17, 3, v3
    ds_write_b64 v17, v[38:39]
    v_add_u32 v18, v18, v34
    v_lshl_add_u32 v18, v18, 3, v3
    ds_write_b64 v18, v[40:41]
    v_add_u32 v19, v19, v35
    v_lshl_add_u32 v19, v19, 3, v3
    ds_write_b64 v19, v[42:43]
    s_mov_b64 exec, -1
    s_waitcnt lgkmcnt(0)
    s_mov_b64 exec, 1
    ds_add_u32 v13, v15 offset:2312
    s_mov_b64 exec, -1
    s_cmp_lt_u32 s64, 14
    s_cbranch_scc1 L_gemm
    s_cmp_eq_u32 s64, 14
    s_cbranch_scc1 L_w14
    s_waitcnt vmcnt(1)
    v_readfirstlane_b32 s3, v48
    v_readfirstlane_b32 s86, v49
    s_cmp_lg_u32 s86, 0
    s_cbranch_scc1 L_ga_ok
    s_waitcnt vmcnt(0)
    v_readfirstlane_b32 s3, v70
    v_readfirstlane_b32 s86, v71
    s_cmp_lg_u32 s86, 0
    s_cbranch_scc1 L_ga_ok
    s_mov_b32 s87, 65536
L_ga:
    buffer_load_dwordx2 v[6:7], v13, s[60:63], 0 offen sc1
    s_waitcnt vmcnt(0)
    v_readfirstlane_b32 s3, v6
    v_readfirstlane_b32 s86, v7
    s_cmp_lg_u32 s86, 0
    s_cbranch_scc1 L_ga_ok
    s_sleep 4
    s_sub_u32 s87, s87, 1
    s_cbranch_scc0 L_ga
L_ga_ok:
    v_or_b32 v72, s3, v10
    v_mov_b32 v73, s86
    v_or_b32 v74, s3, v11
    v_mov_b32 v75, s86
    v_mov_b32 v6, s3
    v_mov_b32 v7, s86
    v_lshlrev_b32 v4, 4, v2
    s_lshl_b32 s75, s2, 10
    s_add_u32 s75, s75, 16060416
    buffer_store_dwordx4 v[72:75], v4, s[28:31], s75 offen sc1
    ds_write_b64 v13, v[6:7] offset:2328
    s_mov_b32 s87, 4194304
L_sb2:
    ds_read_b32 v3, v13 offset:2312
    s_waitcnt lgkmcnt(0)
    v_readfirstlane_b32 s74, v3
    s_cmp_ge_u32 s74, 14
    s_cbranch_scc1 L_sb2_ok
    s_sub_u32 s87, s87, 1
    s_cbranch_scc0 L_sb2
L_sb2_ok:
    v_add_u32 v12, 129664, v4
    ds_read_b128 v[16:19], v12 offset:0
    ds_read_b128 v[20:23], v12 offset:1024
    ds_read_b128 v[24:27], v12 offset:2048
    ds_read_b128 v[28:31], v12 offset:3072
    ds_read_b128 v[32:35], v12 offset:4096
    ds_read_b128 v[36:39], v12 offset:5120
    ds_read_b128 v[40:43], v12 offset:6144
    ds_read_b128 v[44:47], v12 offset:7168
    ds_read_b128 v[48:51], v12 offset:8192
    ds_read_b128 v[52:55], v12 offset:9216
    ds_read_b128 v[56:59], v12 offset:10240
    ds_read_b128 v[60:63], v12 offset:11264
    ds_read_b128 v[64:67], v12 offset:12288
    s_lshr_b32 s80, s3, 12
    s_lshr_b32 s84, s3, 18
    s_lshr_b32 s85, s86, 16
    s_mul_i32 s75, s2, 12544
    s_add_u32 s75, s75, 12849152
    v_mov_b32 v6, 0xfc00
    v_mov_b32 v7, 0xffff
    s_waitcnt lgkmcnt(12)
    v_bfi_b32 v16, v6, s80, v16
    v_bfi_b32 v17, v7, s86, v17
    v_bfi_b32 v18, v6, s84, v18
    v_bfi_b32 v19, v7, s85, v19
    buffer_store_dwordx4 v[16:19], v4, s[28:31], s75 offen offset:0 sc1
    s_waitcnt lgkmcnt(11)
    v_bfi_b32 v20, v6, s80, v20
    v_bfi_b32 v21, v7, s86, v21
    v_bfi_b32 v22, v6, s84, v22
    v_bfi_b32 v23, v7, s85, v23
    buffer_store_dwordx4 v[20:23], v4, s[28:31], s75 offen offset:1024 sc1
    s_waitcnt lgkmcnt(10)
    v_bfi_b32 v24, v6, s80, v24
    v_bfi_b32 v25, v7, s86, v25
    v_bfi_b32 v26, v6, s84, v26
    v_bfi_b32 v27, v7, s85, v27
    buffer_store_dwordx4 v[24:27], v4, s[28:31], s75 offen offset:2048 sc1
    s_waitcnt lgkmcnt(9)
    v_bfi_b32 v28, v6, s80, v28
    v_bfi_b32 v29, v7, s86, v29
    v_bfi_b32 v30, v6, s84, v30
    v_bfi_b32 v31, v7, s85, v31
    buffer_store_dwordx4 v[28:31], v4, s[28:31], s75 offen offset:3072 sc1
    s_add_u32 s75, s75, 4096
    s_waitcnt lgkmcnt(8)
    v_bfi_b32 v32, v6, s80, v32
    v_bfi_b32 v33, v7, s86, v33
    v_bfi_b32 v34, v6, s84, v34
    v_bfi_b32 v35, v7, s85, v35
    buffer_store_dwordx4 v[32:35], v4, s[28:31], s75 offen offset:0 sc1
    s_waitcnt lgkmcnt(7)
    v_bfi_b32 v36, v6, s80, v36
    v_bfi_b32 v37, v7, s86, v37
    v_bfi_b32 v38, v6, s84, v38
    v_bfi_b32 v39, v7, s85, v39
    buffer_store_dwordx4 v[36:39], v4, s[28:31], s75 offen offset:1024 sc1
    s_waitcnt lgkmcnt(6)
    v_bfi_b32 v40, v6, s80, v40
    v_bfi_b32 v41, v7, s86, v41
    v_bfi_b32 v42, v6, s84, v42
    v_bfi_b32 v43, v7, s85, v43
    buffer_store_dwordx4 v[40:43], v4, s[28:31], s75 offen offset:2048 sc1
    s_waitcnt lgkmcnt(5)
    v_bfi_b32 v44, v6, s80, v44
    v_bfi_b32 v45, v7, s86, v45
    v_bfi_b32 v46, v6, s84, v46
    v_bfi_b32 v47, v7, s85, v47
    buffer_store_dwordx4 v[44:47], v4, s[28:31], s75 offen offset:3072 sc1
    s_add_u32 s75, s75, 4096
    s_waitcnt lgkmcnt(4)
    v_bfi_b32 v48, v6, s80, v48
    v_bfi_b32 v49, v7, s86, v49
    v_bfi_b32 v50, v6, s84, v50
    v_bfi_b32 v51, v7, s85, v51
    buffer_store_dwordx4 v[48:51], v4, s[28:31], s75 offen offset:0 sc1
    s_waitcnt lgkmcnt(3)
    v_bfi_b32 v52, v6, s80, v52
    v_bfi_b32 v53, v7, s86, v53
    v_bfi_b32 v54, v6, s84, v54
    v_bfi_b32 v55, v7, s85, v55
    buffer_store_dwordx4 v[52:55], v4, s[28:31], s75 offen offset:1024 sc1
    s_waitcnt lgkmcnt(2)
    v_bfi_b32 v56, v6, s80, v56
    v_bfi_b32 v57, v7, s86, v57
    v_bfi_b32 v58, v6, s84, v58
    v_bfi_b32 v59, v7, s85, v59
    buffer_store_dwordx4 v[56:59], v4, s[28:31], s75 offen offset:2048 sc1
    s_waitcnt lgkmcnt(1)
    v_bfi_b32 v60, v6, s80, v60
    v_bfi_b32 v61, v7, s86, v61
    v_bfi_b32 v62, v6, s84, v62
    v_bfi_b32 v63, v7, s85, v63
    buffer_store_dwordx4 v[60:63], v4, s[28:31], s75 offen offset:3072 sc1
    s_add_u32 s75, s75, 4096
    s_waitcnt lgkmcnt(0)
    v_bfi_b32 v64, v6, s80, v64
    v_bfi_b32 v65, v7, s86, v65
    v_bfi_b32 v66, v6, s84, v66
    v_bfi_b32 v67, v7, s85, v67
    s_mov_b64 exec, 0xffff
    buffer_store_dwordx4 v[64:67], v4, s[28:31], s75 offen offset:0 sc1
    s_mov_b64 exec, -1
    s_cmp_eq_u32 s78, 127
    s_cbranch_scc0 L_rec
    v_lshrrev_b32 v3, 3, v2
    s_mov_b32 s75, 3212288
    v_mul_lo_u32 v3, v3, s75
    v_lshl_add_u32 v3, v1, 4, v3
    s_mov_b32 s75, 3211264
    v_mov_b32 v20, 0x7f007f00
    v_mov_b32 v21, 0x7f007f00
    v_mov_b32 v22, 0
    v_mov_b32 v23, 0
    s_mov_b64 exec, 0xffff
    buffer_store_dwordx4 v[20:23], v3, s[52:55], s75 offen sc1
    s_mov_b64 exec, -1
    s_branch L_rec
L_w14:
    v_lshlrev_b32 v3, 12, v2
    s_lshl_b32 s75, s78, 3
    s_add_u32 s75, s75, 16060416
    s_waitcnt vmcnt(0)
    v_mov_b32 v4, 2
    s_mov_b64 exec, 1
    ds_add_u32 v13, v15 offset:2352
    ds_add_u32 v13, v4 offset:2356
    ds_add_u32 v13, v4 offset:2360
    s_mov_b64 exec, -1
    s_mov_b32 s87, 4194304
L_wtag:
    ds_read_b32 v5, v13 offset:2332
    s_waitcnt lgkmcnt(0)
    v_readfirstlane_b32 s74, v5
    s_cmp_ge_u32 s74, 1
    s_cbranch_scc1 L_wtag_ok
    s_sleep 1
    s_sub_u32 s87, s87, 1
    s_cbranch_scc0 L_wtag
L_wtag_ok:
    ds_read_b32 v5, v13 offset:2328
    s_mov_b32 s86, s74
    s_waitcnt lgkmcnt(0)
    v_readfirstlane_b32 s3, v5
    s_mov_b32 s87, 65536
L_pa:
    buffer_load_dwordx2 v[16:17], v3, s[28:31], s75 offen offset:0 sc1
    buffer_load_dwordx2 v[18:19], v3, s[28:31], s75 offen offset:1024 sc1
    buffer_load_dwordx2 v[20:21], v3, s[28:31], s75 offen offset:2048 sc1
    buffer_load_dwordx2 v[22:23], v3, s[28:31], s75 offen offset:3072 sc1
L_pa1:
    s_waitcnt vmcnt(0)
    v_xor_b32 v24, s3, v16
    v_xor_b32 v17, s86, v17
    v_xor_b32 v25, s3, v18
    v_xor_b32 v19, s86, v19
    v_xor_b32 v26, s3, v20
    v_xor_b32 v21, s86, v21
    v_xor_b32 v27, s3, v22
    v_xor_b32 v23, s86, v23
    v_or3_b32 v6, v24, v25, v26
    v_or_b32 v6, v6, v27
    v_lshrrev_b32 v6, 22, v6
    v_or3_b32 v6, v6, v17, v19
    v_or3_b32 v6, v6, v21, v23
    v_cmpx_ne_u32 vcc, 0, v6
    s_cbranch_execz L_pa_ok
    s_sleep 2
    s_sub_u32 s87, s87, 1
    s_cbranch_scc0 L_pa
L_pa_ok:
    s_mov_b64 exec, -1
    v_lshlrev_b32 v3, 4, v2
    ds_write_b128 v3, v[24:27] offset:4864
    s_waitcnt lgkmcnt(0)
    ds_write_b32 v13, v15 offset:2316
    s_branch L_rec
L_gemm:
    s_setprio 0
    v_lshrrev_b32 v12, 4, v2
    v_lshlrev_b32 v3, 2, v12
    v_and_b32 v4, 15, v2
    v_xor_b32 v3, v3, v4
    v_lshlrev_b32 v3, 4, v3
    v_lshl_add_u32 v12, v12, 8, v3
    s_mov_b32 s87, 4194304
L_wi:
    ds_read_b32 v3, v13 offset:2372
    s_waitcnt lgkmcnt(0)
    v_readfirstlane_b32 s74, v3
    s_cmp_ge_u32 s74, 8
    s_cbranch_scc1 L_wi_ok
    s_sub_u32 s87, s87, 1
    s_cbranch_scc0 L_wi
L_wi_ok:
    s_lshr_b32 s82, s64, 1
    s_and_b32 s83, s64, 1
    s_add_u32 s81, s67, s83
    s_lshl_b32 s74, s64, 4
    s_add_u32 s74, s74, s79
    s_lshl_b32 s74, s74, 8
    s_mul_i32 s76, s82, 8320
    s_add_u32 s76, s76, 5888
    s_mul_i32 s75, s83, 4160
    s_add_u32 s75, s75, s76
    s_cmp_ge_u32 s64, 9
    s_cbranch_scc1 L_xdone
    s_add_u32 m0, s75, 0
    s_nop 0
    buffer_load_dwordx4 v12, s[48:51], s74 offen offset:0 lds
    s_add_u32 m0, s75, 16
    s_nop 0
    buffer_load_dwordx4 v12, s[48:51], s74 offen offset:1024 lds
    s_add_u32 m0, s75, 32
    s_nop 0
    buffer_load_dwordx4 v12, s[48:51], s74 offen offset:2048 lds
    s_add_u32 m0, s75, 48
    s_nop 0
    buffer_load_dwordx4 v12, s[48:51], s74 offen offset:3072 lds
L_xdone:
    s_cmp_lt_u32 s64, 8
    s_cbranch_scc0 L_w4
    s_waitcnt vmcnt(4)
    s_mov_b64 exec, 1
    ds_add_u32 v13, v15 offset:2320
    s_mov_b64 exec, -1
L_w4:
    v_and_b32 v6, 31, v2
    v_lshrrev_b32 v7, 5, v2
    v_lshrrev_b32 v3, 2, v6
    s_movk_i32 s74, 1040
    v_mul_u32_u24 v3, s74, v3
    v_and_b32 v12, 3, v6
    v_lshl_add_u32 v3, v12, 8, v3
    v_lshl_add_u32 v3, v7, 4, v3
    v_add_u32 v3, s76, v3
    v_xor_b32 v12, s81, v12
    v_xor_b32 v4, 0, v12
    v_lshl_add_u32 v96, v4, 6, v3
    v_xor_b32 v4, 1, v12
    v_lshl_add_u32 v97, v4, 6, v3
    v_xor_b32 v4, 2, v12
    v_lshl_add_u32 v98, v4, 6, v3
    v_xor_b32 v4, 3, v12
    v_lshl_add_u32 v99, v4, 6, v3
    v_bfe_u32 v3, v2, 2, 2
    v_lshl_add_u32 v8, v7, 3, v3
    v_lshlrev_b32 v8, 7, v8
    v_lshrrev_b32 v3, 1, v3
    v_xor_b32 v3, s83, v3
    v_lshl_add_u32 v8, v3, 6, v8
    v_bfe_u32 v3, v2, 4, 1
    v_lshl_add_u32 v8, v3, 5, v8
    v_and_b32 v3, 3, v2
    v_lshl_add_u32 v8, v3, 3, v8
    s_xor_b32 s74, s81, 0
    s_lshl_b32 s74, s74, 12
    s_add_u32 s74, s74, 64128
    v_add_u32 v120, s74, v8
    s_xor_b32 s74, s81, 1
    s_lshl_b32 s74, s74, 12
    s_add_u32 s74, s74, 64128
    v_add_u32 v121, s74, v8
    s_xor_b32 s74, s81, 2
    s_lshl_b32 s74, s74, 12
    s_add_u32 s74, s74, 64128
    v_add_u32 v122, s74, v8
    s_xor_b32 s74, s81, 3
    s_lshl_b32 s74, s74, 12
    s_add_u32 s74, s74, 64128
    v_add_u32 v123, s74, v8
    s_lshl_b32 s74, s82, 2
    v_mov_b32 v11, s74
    s_lshl_b32 s77, s83, 12
    s_add_u32 s77, s77, s76
    s_waitcnt vmcnt(0)
    s_cmp_ge_u32 s64, 9
    s_cbranch_scc1 L_noinc
    s_mov_b64 exec, 1
    ds_add_u32 v11, v15 offset:2336
    s_mov_b64 exec, -1
L_noinc:
    s_mov_b32 s87, 4194304
L_wt:
    ds_read_b32 v3, v11 offset:2336
    s_waitcnt lgkmcnt(0)
    v_readfirstlane_b32 s74, v3
    s_cmp_ge_u32 s74, 2
    s_cbranch_scc1 L_wt_ok
    s_sub_u32 s87, s87, 1
    s_cbranch_scc0 L_wt
L_wt_ok:
    ds_read_b128 v[16:19], v96 offset:0
    ds_read_b128 v[20:23], v96 offset:32
    ds_read_b128 v[24:27], v97 offset:0
    ds_read_b128 v[28:31], v97 offset:32
    ds_read_b128 v[32:35], v98 offset:0
    ds_read_b128 v[36:39], v98 offset:32
    ds_read_b128 v[40:43], v99 offset:0
    ds_read_b128 v[44:47], v99 offset:32
    s_waitcnt lgkmcnt(0)
    s_mov_b64 exec, 1
    ds_add_u32 v11, v15 offset:2336
    s_mov_b64 exec, -1
    s_mov_b32 s87, 4194304
L_ww:
    ds_read_b32 v3, v13 offset:2320
    s_waitcnt lgkmcnt(0)
    v_readfirstlane_b32 s74, v3
    s_cmp_ge_u32 s74, 8
    s_cbranch_scc1 L_ww_ok
    s_sleep 1
    s_sub_u32 s87, s87, 1
    s_cbranch_scc0 L_ww
L_ww_ok:
    ds_read_b64_tr_b16 v[48:49], v120 offset:0
    ds_read_b64_tr_b16 v[50:51], v120 offset:512
    ds_read_b64_tr_b16 v[52:53], v120 offset:16384
    ds_read_b64_tr_b16 v[54:55], v120 offset:16896
    ds_read_b64_tr_b16 v[56:57], v120 offset:2048
    ds_read_b64_tr_b16 v[58:59], v120 offset:2560
    ds_read_b64_tr_b16 v[60:61], v120 offset:18432
    ds_read_b64_tr_b16 v[62:63], v120 offset:18944
    s_waitcnt lgkmcnt(4)
    v_mfma_f32_32x32x16_bf16 v[64:79], v[48:51], v[16:19], 0
    v_mfma_f32_32x32x16_bf16 v[80:95], v[52:55], v[16:19], 0
    ds_read_b64_tr_b16 v[48:49], v121 offset:0
    ds_read_b64_tr_b16 v[50:51], v121 offset:512
    ds_read_b64_tr_b16 v[52:53], v121 offset:16384
    ds_read_b64_tr_b16 v[54:55], v121 offset:16896
    s_waitcnt lgkmcnt(4)
    v_mfma_f32_32x32x16_bf16 v[64:79], v[56:59], v[20:23], v[64:79]
    v_mfma_f32_32x32x16_bf16 v[80:95], v[60:63], v[20:23], v[80:95]
    ds_read_b64_tr_b16 v[56:57], v121 offset:2048
    ds_read_b64_tr_b16 v[58:59], v121 offset:2560
    ds_read_b64_tr_b16 v[60:61], v121 offset:18432
    ds_read_b64_tr_b16 v[62:63], v121 offset:18944
    s_waitcnt lgkmcnt(4)
    v_mfma_f32_32x32x16_bf16 v[64:79], v[48:51], v[24:27], v[64:79]
    v_mfma_f32_32x32x16_bf16 v[80:95], v[52:55], v[24:27], v[80:95]
    ds_read_b64_tr_b16 v[48:49], v122 offset:0
    ds_read_b64_tr_b16 v[50:51], v122 offset:512
    ds_read_b64_tr_b16 v[52:53], v122 offset:16384
    ds_read_b64_tr_b16 v[54:55], v122 offset:16896
    s_waitcnt lgkmcnt(4)
    v_mfma_f32_32x32x16_bf16 v[64:79], v[56:59], v[28:31], v[64:79]
    v_mfma_f32_32x32x16_bf16 v[80:95], v[60:63], v[28:31], v[80:95]
    ds_read_b64_tr_b16 v[56:57], v122 offset:2048
    ds_read_b64_tr_b16 v[58:59], v122 offset:2560
    ds_read_b64_tr_b16 v[60:61], v122 offset:18432
    ds_read_b64_tr_b16 v[62:63], v122 offset:18944
    s_waitcnt lgkmcnt(4)
    v_mfma_f32_32x32x16_bf16 v[64:79], v[48:51], v[32:35], v[64:79]
    v_mfma_f32_32x32x16_bf16 v[80:95], v[52:55], v[32:35], v[80:95]
    ds_read_b64_tr_b16 v[48:49], v123 offset:0
    ds_read_b64_tr_b16 v[50:51], v123 offset:512
    ds_read_b64_tr_b16 v[52:53], v123 offset:16384
    ds_read_b64_tr_b16 v[54:55], v123 offset:16896
    s_waitcnt lgkmcnt(4)
    v_mfma_f32_32x32x16_bf16 v[64:79], v[56:59], v[36:39], v[64:79]
    v_mfma_f32_32x32x16_bf16 v[80:95], v[60:63], v[36:39], v[80:95]
    ds_read_b64_tr_b16 v[56:57], v123 offset:2048
    ds_read_b64_tr_b16 v[58:59], v123 offset:2560
    ds_read_b64_tr_b16 v[60:61], v123 offset:18432
    ds_read_b64_tr_b16 v[62:63], v123 offset:18944
    s_waitcnt lgkmcnt(4)
    v_mfma_f32_32x32x16_bf16 v[64:79], v[48:51], v[40:43], v[64:79]
    v_mfma_f32_32x32x16_bf16 v[80:95], v[52:55], v[40:43], v[80:95]
    s_waitcnt lgkmcnt(0)
    v_mfma_f32_32x32x16_bf16 v[64:79], v[56:59], v[44:47], v[64:79]
    v_mfma_f32_32x32x16_bf16 v[80:95], v[60:63], v[44:47], v[80:95]
    s_nop 15
    v_pk_fma_f32 v[64:65], v[64:65], s[68:69], s[68:69] op_sel:[0,0,1] op_sel_hi:[1,0,1]
    v_pk_fma_f32 v[66:67], v[66:67], s[68:69], s[68:69] op_sel:[0,0,1] op_sel_hi:[1,0,1]
    v_pk_fma_f32 v[68:69], v[68:69], s[68:69], s[68:69] op_sel:[0,0,1] op_sel_hi:[1,0,1]
    v_pk_fma_f32 v[70:71], v[70:71], s[68:69], s[68:69] op_sel:[0,0,1] op_sel_hi:[1,0,1]
    v_pk_fma_f32 v[72:73], v[72:73], s[68:69], s[68:69] op_sel:[0,0,1] op_sel_hi:[1,0,1]
    v_pk_fma_f32 v[74:75], v[74:75], s[68:69], s[68:69] op_sel:[0,0,1] op_sel_hi:[1,0,1]
    v_pk_fma_f32 v[76:77], v[76:77], s[68:69], s[68:69] op_sel:[0,0,1] op_sel_hi:[1,0,1]
    v_pk_fma_f32 v[78:79], v[78:79], s[68:69], s[68:69] op_sel:[0,0,1] op_sel_hi:[1,0,1]
    v_pk_add_f32 v[80:81], v[80:81], s[68:69] op_sel:[0,1] op_sel_hi:[1,1]
    v_pk_add_f32 v[82:83], v[82:83], s[68:69] op_sel:[0,1] op_sel_hi:[1,1]
    v_pk_add_f32 v[84:85], v[84:85], s[68:69] op_sel:[0,1] op_sel_hi:[1,1]
    v_pk_add_f32 v[86:87], v[86:87], s[68:69] op_sel:[0,1] op_sel_hi:[1,1]
    v_pk_add_f32 v[88:89], v[88:89], s[68:69] op_sel:[0,1] op_sel_hi:[1,1]
    v_pk_add_f32 v[90:91], v[90:91], s[68:69] op_sel:[0,1] op_sel_hi:[1,1]
    v_pk_add_f32 v[92:93], v[92:93], s[68:69] op_sel:[0,1] op_sel_hi:[1,1]
    v_pk_add_f32 v[94:95], v[94:95], s[68:69] op_sel:[0,1] op_sel_hi:[1,1]
    s_mov_b32 s87, 4194304
L_wu:
    ds_read_b32 v3, v11 offset:2336
    s_waitcnt lgkmcnt(0)
    v_readfirstlane_b32 s74, v3
    s_cmp_ge_u32 s74, 4
    s_cbranch_scc1 L_wu_ok
    s_sub_u32 s87, s87, 1
    s_cbranch_scc0 L_wu
L_wu_ok:
    v_and_b32 v3, 7, v6
    v_xor_b32 v3, v3, v7
    v_lshlrev_b32 v3, 4, v3
    v_lshl_add_u32 v3, v6, 7, v3
    v_add_u32 v3, s77, v3
    v_add_u32 v64, s65, v64
    v_add_u32 v65, s65, v65
    v_add_u32 v66, s65, v66
    v_add_u32 v67, s65, v67
    v_sub_u32_sdwa v65, v65, v64 dst_sel:DWORD dst_unused:UNUSED_PAD src0_sel:DWORD src1_sel:WORD_1
    v_sub_u32_sdwa v66, v66, v65 dst_sel:DWORD dst_unused:UNUSED_PAD src0_sel:DWORD src1_sel:WORD_1
    v_sub_u32_sdwa v67, v67, v66 dst_sel:DWORD dst_unused:UNUSED_PAD src0_sel:DWORD src1_sel:WORD_1
    v_perm_b32 v96, v65, v64, s66
    v_perm_b32 v97, v67, v66, s66
    v_add_u32 v80, s65, v80
    v_add_u32 v81, s65, v81
    v_add_u32 v82, s65, v82
    v_add_u32 v83, s65, v83
    v_sub_u32_sdwa v81, v81, v80 dst_sel:DWORD dst_unused:UNUSED_PAD src0_sel:DWORD src1_sel:WORD_1
    v_sub_u32_sdwa v82, v82, v81 dst_sel:DWORD dst_unused:UNUSED_PAD src0_sel:DWORD src1_sel:WORD_1
    v_sub_u32_sdwa v83, v83, v82 dst_sel:DWORD dst_unused:UNUSED_PAD src0_sel:DWORD src1_sel:WORD_1
    v_perm_b32 v98, v81, v80, s66
    v_perm_b32 v99, v83, v82, s66
    ds_write_b128 v3, v[96:99]
    v_add_u32 v68, s65, v68
    v_add_u32 v69, s65, v69
    v_add_u32 v70, s65, v70
    v_add_u32 v71, s65, v71
    v_sub_u32_sdwa v69, v69, v68 dst_sel:DWORD dst_unused:UNUSED_PAD src0_sel:DWORD src1_sel:WORD_1
    v_sub_u32_sdwa v70, v70, v69 dst_sel:DWORD dst_unused:UNUSED_PAD src0_sel:DWORD src1_sel:WORD_1
    v_sub_u32_sdwa v71, v71, v70 dst_sel:DWORD dst_unused:UNUSED_PAD src0_sel:DWORD src1_sel:WORD_1
    v_perm_b32 v100, v69, v68, s66
    v_perm_b32 v101, v71, v70, s66
    v_add_u32 v84, s65, v84
    v_add_u32 v85, s65, v85
    v_add_u32 v86, s65, v86
    v_add_u32 v87, s65, v87
    v_sub_u32_sdwa v85, v85, v84 dst_sel:DWORD dst_unused:UNUSED_PAD src0_sel:DWORD src1_sel:WORD_1
    v_sub_u32_sdwa v86, v86, v85 dst_sel:DWORD dst_unused:UNUSED_PAD src0_sel:DWORD src1_sel:WORD_1
    v_sub_u32_sdwa v87, v87, v86 dst_sel:DWORD dst_unused:UNUSED_PAD src0_sel:DWORD src1_sel:WORD_1
    v_perm_b32 v102, v85, v84, s66
    v_perm_b32 v103, v87, v86, s66
    v_xor_b32 v3, 32, v3
    ds_write_b128 v3, v[100:103]
    v_add_u32 v72, s65, v72
    v_add_u32 v73, s65, v73
    v_add_u32 v74, s65, v74
    v_add_u32 v75, s65, v75
    v_sub_u32_sdwa v73, v73, v72 dst_sel:DWORD dst_unused:UNUSED_PAD src0_sel:DWORD src1_sel:WORD_1
    v_sub_u32_sdwa v74, v74, v73 dst_sel:DWORD dst_unused:UNUSED_PAD src0_sel:DWORD src1_sel:WORD_1
    v_sub_u32_sdwa v75, v75, v74 dst_sel:DWORD dst_unused:UNUSED_PAD src0_sel:DWORD src1_sel:WORD_1
    v_perm_b32 v96, v73, v72, s66
    v_perm_b32 v97, v75, v74, s66
    v_add_u32 v88, s65, v88
    v_add_u32 v89, s65, v89
    v_add_u32 v90, s65, v90
    v_add_u32 v91, s65, v91
    v_sub_u32_sdwa v89, v89, v88 dst_sel:DWORD dst_unused:UNUSED_PAD src0_sel:DWORD src1_sel:WORD_1
    v_sub_u32_sdwa v90, v90, v89 dst_sel:DWORD dst_unused:UNUSED_PAD src0_sel:DWORD src1_sel:WORD_1
    v_sub_u32_sdwa v91, v91, v90 dst_sel:DWORD dst_unused:UNUSED_PAD src0_sel:DWORD src1_sel:WORD_1
    v_perm_b32 v98, v89, v88, s66
    v_perm_b32 v99, v91, v90, s66
    v_xor_b32 v3, 96, v3
    ds_write_b128 v3, v[96:99]
    v_add_u32 v76, s65, v76
    v_add_u32 v77, s65, v77
    v_add_u32 v78, s65, v78
    v_add_u32 v79, s65, v79
    v_sub_u32_sdwa v77, v77, v76 dst_sel:DWORD dst_unused:UNUSED_PAD src0_sel:DWORD src1_sel:WORD_1
    v_sub_u32_sdwa v78, v78, v77 dst_sel:DWORD dst_unused:UNUSED_PAD src0_sel:DWORD src1_sel:WORD_1
    v_sub_u32_sdwa v79, v79, v78 dst_sel:DWORD dst_unused:UNUSED_PAD src0_sel:DWORD src1_sel:WORD_1
    v_perm_b32 v100, v77, v76, s66
    v_perm_b32 v101, v79, v78, s66
    v_add_u32 v92, s65, v92
    v_add_u32 v93, s65, v93
    v_add_u32 v94, s65, v94
    v_add_u32 v95, s65, v95
    v_sub_u32_sdwa v93, v93, v92 dst_sel:DWORD dst_unused:UNUSED_PAD src0_sel:DWORD src1_sel:WORD_1
    v_sub_u32_sdwa v94, v94, v93 dst_sel:DWORD dst_unused:UNUSED_PAD src0_sel:DWORD src1_sel:WORD_1
    v_sub_u32_sdwa v95, v95, v94 dst_sel:DWORD dst_unused:UNUSED_PAD src0_sel:DWORD src1_sel:WORD_1
    v_perm_b32 v102, v93, v92, s66
    v_perm_b32 v103, v95, v94, s66
    v_xor_b32 v3, 32, v3
    ds_write_b128 v3, v[100:103]
    v_lshrrev_b32 v3, 3, v2
    v_xor_b32 v10, v1, v3
    v_lshlrev_b32 v10, 4, v10
    v_lshl_add_u32 v10, v3, 7, v10
    v_add_u32 v10, s77, v10
    s_lshl_b32 s89, s82, 5
    s_add_u32 s89, s89, s79
    s_lshl_b32 s89, s89, 7
    s_mul_i32 s74, s83, 3212288
    s_add_u32 s89, s89, s74
    s_waitcnt lgkmcnt(0)
    ds_read_b128 v[64:67], v10 offset:0
    ds_read_b128 v[68:71], v10 offset:1024
    ds_read_b128 v[72:75], v10 offset:2048
    ds_read_b128 v[76:79], v10 offset:3072
    v_lshlrev_b32 v3, 4, v2
    s_cmp_lt_u32 s64, 12
    s_cbranch_scc1 L_st_done_full
    s_waitcnt lgkmcnt(0)
    s_mov_b32 exec_hi, 0
    buffer_store_dwordx4 v[64:67], v3, s[52:55], s89 offen sc1
    s_mov_b64 exec, -1
    s_branch L_st_done
L_st_done_full:
    s_waitcnt lgkmcnt(3)
    buffer_store_dwordx4 v[64:67], v3, s[52:55], s89 offen offset:0 sc1
    s_waitcnt lgkmcnt(2)
    buffer_store_dwordx4 v[68:71], v3, s[52:55], s89 offen offset:1024 sc1
    s_waitcnt lgkmcnt(1)
    buffer_store_dwordx4 v[72:75], v3, s[52:55], s89 offen offset:2048 sc1
    s_waitcnt lgkmcnt(0)
    buffer_store_dwordx4 v[76:79], v3, s[52:55], s89 offen offset:3072 sc1
L_st_done:
    ds_read_b64_tr_b16 v[48:49], v120 offset:32768
    ds_read_b64_tr_b16 v[50:51], v120 offset:33280
    ds_read_b64_tr_b16 v[52:53], v120 offset:49152
    ds_read_b64_tr_b16 v[54:55], v120 offset:49664
    ds_read_b64_tr_b16 v[56:57], v120 offset:34816
    ds_read_b64_tr_b16 v[58:59], v120 offset:35328
    ds_read_b64_tr_b16 v[60:61], v120 offset:51200
    ds_read_b64_tr_b16 v[62:63], v120 offset:51712
    s_waitcnt lgkmcnt(4)
    v_mfma_f32_32x32x16_bf16 v[64:79], v[48:51], v[16:19], 0
    v_mfma_f32_32x32x16_bf16 v[80:95], v[52:55], v[16:19], 0
    ds_read_b64_tr_b16 v[48:49], v121 offset:32768
    ds_read_b64_tr_b16 v[50:51], v121 offset:33280
    ds_read_b64_tr_b16 v[52:53], v121 offset:49152
    ds_read_b64_tr_b16 v[54:55], v121 offset:49664
    s_waitcnt lgkmcnt(4)
    v_mfma_f32_32x32x16_bf16 v[64:79], v[56:59], v[20:23], v[64:79]
    v_mfma_f32_32x32x16_bf16 v[80:95], v[60:63], v[20:23], v[80:95]
    ds_read_b64_tr_b16 v[56:57], v121 offset:34816
    ds_read_b64_tr_b16 v[58:59], v121 offset:35328
    ds_read_b64_tr_b16 v[60:61], v121 offset:51200
    ds_read_b64_tr_b16 v[62:63], v121 offset:51712
    s_waitcnt lgkmcnt(4)
    v_mfma_f32_32x32x16_bf16 v[64:79], v[48:51], v[24:27], v[64:79]
    v_mfma_f32_32x32x16_bf16 v[80:95], v[52:55], v[24:27], v[80:95]
    ds_read_b64_tr_b16 v[48:49], v122 offset:32768
    ds_read_b64_tr_b16 v[50:51], v122 offset:33280
    ds_read_b64_tr_b16 v[52:53], v122 offset:49152
    ds_read_b64_tr_b16 v[54:55], v122 offset:49664
    s_waitcnt lgkmcnt(4)
    v_mfma_f32_32x32x16_bf16 v[64:79], v[56:59], v[28:31], v[64:79]
    v_mfma_f32_32x32x16_bf16 v[80:95], v[60:63], v[28:31], v[80:95]
    ds_read_b64_tr_b16 v[56:57], v122 offset:34816
    ds_read_b64_tr_b16 v[58:59], v122 offset:35328
    ds_read_b64_tr_b16 v[60:61], v122 offset:51200
    ds_read_b64_tr_b16 v[62:63], v122 offset:51712
    s_waitcnt lgkmcnt(4)
    v_mfma_f32_32x32x16_bf16 v[64:79], v[48:51], v[32:35], v[64:79]
    v_mfma_f32_32x32x16_bf16 v[80:95], v[52:55], v[32:35], v[80:95]
    ds_read_b64_tr_b16 v[48:49], v123 offset:32768
    ds_read_b64_tr_b16 v[50:51], v123 offset:33280
    ds_read_b64_tr_b16 v[52:53], v123 offset:49152
    ds_read_b64_tr_b16 v[54:55], v123 offset:49664
    s_waitcnt lgkmcnt(4)
    v_mfma_f32_32x32x16_bf16 v[64:79], v[56:59], v[36:39], v[64:79]
    v_mfma_f32_32x32x16_bf16 v[80:95], v[60:63], v[36:39], v[80:95]
    ds_read_b64_tr_b16 v[56:57], v123 offset:34816
    ds_read_b64_tr_b16 v[58:59], v123 offset:35328
    ds_read_b64_tr_b16 v[60:61], v123 offset:51200
    ds_read_b64_tr_b16 v[62:63], v123 offset:51712
    s_waitcnt lgkmcnt(4)
    v_mfma_f32_32x32x16_bf16 v[64:79], v[48:51], v[40:43], v[64:79]
    v_mfma_f32_32x32x16_bf16 v[80:95], v[52:55], v[40:43], v[80:95]
    s_waitcnt lgkmcnt(0)
    v_mfma_f32_32x32x16_bf16 v[64:79], v[56:59], v[44:47], v[64:79]
    v_mfma_f32_32x32x16_bf16 v[80:95], v[60:63], v[44:47], v[80:95]
    s_nop 15
    v_pk_mul_f32 v[64:65], v[64:65], s[68:69] op_sel_hi:[1,0]
    v_pk_mul_f32 v[66:67], v[66:67], s[68:69] op_sel_hi:[1,0]
    v_pk_mul_f32 v[68:69], v[68:69], s[68:69] op_sel_hi:[1,0]
    v_pk_mul_f32 v[70:71], v[70:71], s[68:69] op_sel_hi:[1,0]
    v_pk_mul_f32 v[72:73], v[72:73], s[68:69] op_sel_hi:[1,0]
    v_pk_mul_f32 v[74:75], v[74:75], s[68:69] op_sel_hi:[1,0]
    v_pk_mul_f32 v[76:77], v[76:77], s[68:69] op_sel_hi:[1,0]
    v_pk_mul_f32 v[78:79], v[78:79], s[68:69] op_sel_hi:[1,0]
    v_cvt_pk_bf16_f32 v50, v80, v81
    v_cvt_pk_bf16_f32 v51, v82, v83
    v_cvt_pk_bf16_f32 v54, v84, v85
    v_cvt_pk_bf16_f32 v55, v86, v87
    v_cvt_pk_bf16_f32 v58, v88, v89
    v_cvt_pk_bf16_f32 v59, v90, v91
    v_cvt_pk_bf16_f32 v62, v92, v93
    v_cvt_pk_bf16_f32 v63, v94, v95
    v_max3_f32 v3, |v64|, |v65|, |v66|
    v_max3_f32 v3, v3, |v67|, |v68|
    v_max3_f32 v3, v3, |v69|, |v70|
    v_max3_f32 v3, v3, |v71|, |v72|
    v_max3_f32 v3, v3, |v73|, |v74|
    v_max3_f32 v3, v3, |v75|, |v76|
    v_max3_f32 v3, v3, |v77|, |v78|
    v_max_f32 v3, v3, |v79|
    s_mov_b32 s74, 0x42700000
    s_cmp_ge_u32 s64, 12
    s_cselect_b32 s70, 0xf, -1
    v_cmp_lt_f32 vcc, s74, v3
    s_mov_b32 s71, s70
    s_and_b64 vcc, vcc, s[70:71]
    s_cbranch_scc0 L_doexp
    v_lshlrev_b32 v3, s64, v15
    ds_or_b32 v13, v3 offset:2308
    s_branch L_noexp
L_doexp:
    v_exp_f32 v64, -v64
    v_exp_f32 v65, -v65
    v_exp_f32 v66, -v66
    v_exp_f32 v67, -v67
    v_exp_f32 v68, -v68
    v_exp_f32 v69, -v69
    v_exp_f32 v70, -v70
    v_exp_f32 v71, -v71
    v_exp_f32 v72, -v72
    v_exp_f32 v73, -v73
    v_exp_f32 v74, -v74
    v_exp_f32 v75, -v75
    v_exp_f32 v76, -v76
    v_exp_f32 v77, -v77
    v_exp_f32 v78, -v78
    v_exp_f32 v79, -v79
L_noexp:
    v_cvt_pk_bf16_f32 v48, v64, v65
    v_cvt_pk_bf16_f32 v49, v66, v67
    v_cvt_pk_bf16_f32 v52, v68, v69
    v_cvt_pk_bf16_f32 v53, v70, v71
    v_cvt_pk_bf16_f32 v56, v72, v73
    v_cvt_pk_bf16_f32 v57, v74, v75
    v_cvt_pk_bf16_f32 v60, v76, v77
    v_cvt_pk_bf16_f32 v61, v78, v79
    s_mov_b64 exec, 1
    ds_add_u32 v13, v15 offset:2368
    s_mov_b64 exec, -1
L_rec:
    v_and_b32 v5, 3, v0
    v_lshrrev_b32 v3, 2, v0
    s_movk_i32 s74, 12544
    v_mul_u32_u24 v12, s74, v3
    v_lshl_add_u32 v12, v5, 4, v12
    v_lshlrev_b32 v5, 1, v5
    v_and_b32 v14, 0xffc, v0
    s_mov_b32 s87, 4194304
L_wo:
    ds_read_b32 v3, v13 offset:2316
    s_waitcnt lgkmcnt(0)
    v_readfirstlane_b32 s74, v3
    s_cmp_ge_u32 s74, 1
    s_cbranch_scc1 L_wo_ok
    s_sleep 1
    s_sub_u32 s87, s87, 1
    s_cbranch_scc0 L_wo
L_wo_ok:
    ds_read_b32 v4, v14 offset:4864
    ds_read_b64 v[6:7], v13 offset:2328
    s_waitcnt lgkmcnt(0)
    v_readfirstlane_b32 s3, v6
    v_readfirstlane_b32 s86, v7
    v_and_b32 v3, 0x7fe, v4
    v_lshl_add_u32 v12, v3, 3, v12
    v_and_b32 v3, 1, v4
    v_sub_u32 v5, v5, v3
    v_lshrrev_b32 v4, 11, v4
    v_cmp_le_i32 vcc, 0, v5
    v_sub_u32 v5, v4, v5
    v_cmp_lt_i32 s[4:5], 0, v5
    v_cmp_lt_i32 s[6:7], 1, v5
    v_cmp_lt_i32 s[8:9], 8, v5
    v_cmp_lt_i32 s[10:11], 9, v5
    v_cmp_lt_i32 s[12:13], 16, v5
    v_cmp_lt_i32 s[14:15], 17, v5
    v_cmp_lt_i32 s[16:17], 24, v5
    v_cmp_lt_i32 s[18:19], 25, v5
    v_cmp_lt_i32 s[20:21], 32, v5
    v_cmp_lt_i32 s[22:23], 33, v5
    s_mov_b64 s[70:71], s[4:5]
    s_and_b64 s[4:5], s[4:5], vcc
    s_mov_b32 s74, 12849152
    s_mov_b64 exec, s[70:71]
    buffer_load_dwordx4 v[104:107], v12, s[28:31], s74 offen offset:0 sc1
    s_mov_b64 exec, s[8:9]
    buffer_load_dwordx4 v[108:111], v12, s[28:31], s74 offen offset:64 sc1
    s_mov_b64 exec, s[12:13]
    s_cbranch_execz L_ld_done
    buffer_load_dwordx4 v[112:115], v12, s[28:31], s74 offen offset:128 sc1
    s_mov_b64 exec, s[16:17]
    s_cbranch_execz L_ld_done
    buffer_load_dwordx4 v[116:119], v12, s[28:31], s74 offen offset:192 sc1
    s_mov_b64 exec, s[20:21]
    s_cbranch_execz L_ld_done
    buffer_load_dwordx4 v[120:123], v12, s[28:31], s74 offen offset:256 sc1
L_ld_done:
    s_mov_b64 exec, -1
    v_cmpx_lt_u32 vcc, 39, v4
    ds_write_b32 v13, v15 offset:2304
    s_mov_b64 exec, -1
    s_cmp_lt_u32 s64, 14
    s_cbranch_scc0 L_noaux
    s_mov_b32 s87, 4194304
L_wg:
    ds_read_b32 v3, v13 offset:2368
    s_waitcnt lgkmcnt(0)
    v_readfirstlane_b32 s74, v3
    s_cmp_ge_u32 s74, 14
    s_cbranch_scc1 L_wg_ok
    s_sleep 1
    s_sub_u32 s87, s87, 1
    s_cbranch_scc0 L_wg
L_wg_ok:
    s_cmp_lt_u32 s64, 14
    s_cbranch_scc0 L_noaux
    s_lshr_b32 s74, s64, 1
    s_lshl_b32 s74, s74, 5
    v_and_b32 v3, 31, v2
    v_add_u32 v3, s74, v3
    s_movk_i32 s74, 200
    v_cmpx_gt_u32 vcc, s74, v3
    s_and_b32 s75, s64, 1
    s_mul_i32 s75, s75, 40000
    s_add_u32 s75, s75, 5888
    v_mul_u32_u24 v3, s74, v3
    v_lshrrev_b32 v14, 5, v2
    v_mul_u32_u24 v14, 24, v14
    v_add3_u32 v3, v3, v14, s75
    v_add_u32 v14, v3, v14
    ds_write2_b64 v3, v[48:49], v[50:51] offset0:0 offset1:1
    ds_write2_b64 v3, v[52:53], v[54:55] offset0:6 offset1:7
    ds_write2_b64 v3, v[56:57], v[58:59] offset0:12 offset1:13
    ds_write2_b64 v3, v[60:61], v[62:63] offset0:18 offset1:19
    ds_write2_b64 v14, v[16:17], v[18:19] offset0:2 offset1:5
    ds_write2_b64 v14, v[20:21], v[22:23] offset0:14 offset1:17
    s_mov_b64 exec, -1
L_noaux:
    s_lshr_b32 s80, s3, 12
    s_lshr_b32 s84, s3, 18
    s_lshr_b32 s85, s86, 16
    s_and_b32 s80, s80, 0xfc00
    s_and_b32 s84, s84, 0xfc00
    s_lshl_b32 s84, s84, 16
    s_or_b32 s80, s80, s84
    s_mov_b32 s84, 0x05040100
    v_mov_b32 v7, 0xfc00fc00
    s_mov_b32 s87, 65536
L_chk:
    v_mov_b32 v6, 0
    s_waitcnt vmcnt(0)
    s_mov_b64 exec, s[70:71]
    v_perm_b32 v3, v106, v104, s84
    v_perm_b32 v14, v107, v105, s84
    v_xor_b32 v3, s80, v3
    v_xor_b32 v14, s86, v14
    v_and_or_b32 v3, v3, v7, v14
    v_or_b32 v6, v6, v3
    s_mov_b64 exec, s[8:9]
    v_perm_b32 v3, v110, v108, s84
    v_perm_b32 v14, v111, v109, s84
    v_xor_b32 v3, s80, v3
    v_xor_b32 v14, s86, v14
    v_and_or_b32 v3, v3, v7, v14
    v_or_b32 v6, v6, v3
    s_mov_b64 exec, s[12:13]
    s_cbranch_execz L_chk_done
    v_perm_b32 v3, v114, v112, s84
    v_perm_b32 v14, v115, v113, s84
    v_xor_b32 v3, s80, v3
    v_xor_b32 v14, s86, v14
    v_and_or_b32 v3, v3, v7, v14
    v_or_b32 v6, v6, v3
    s_mov_b64 exec, s[16:17]
    s_cbranch_execz L_chk_done
    v_perm_b32 v3, v118, v116, s84
    v_perm_b32 v14, v119, v117, s84
    v_xor_b32 v3, s80, v3
    v_xor_b32 v14, s86, v14
    v_and_or_b32 v3, v3, v7, v14
    v_or_b32 v6, v6, v3
    s_mov_b64 exec, s[20:21]
    s_cbranch_execz L_chk_done
    v_perm_b32 v3, v122, v120, s84
    v_perm_b32 v14, v123, v121, s84
    v_xor_b32 v3, s80, v3
    v_xor_b32 v14, s86, v14
    v_and_or_b32 v3, v3, v7, v14
    v_or_b32 v6, v6, v3
L_chk_done:
    s_mov_b64 exec, -1
    v_cmp_ne_u32 vcc, 0, v6
    s_cbranch_vccz L_chk_ok
    s_mov_b32 s74, 12849152
    s_mov_b64 exec, s[70:71]
    buffer_load_dwordx4 v[104:107], v12, s[28:31], s74 offen offset:0 sc1
    s_mov_b64 exec, s[8:9]
    buffer_load_dwordx4 v[108:111], v12, s[28:31], s74 offen offset:64 sc1
    s_mov_b64 exec, s[12:13]
    s_cbranch_execz L_ld_again
    buffer_load_dwordx4 v[112:115], v12, s[28:31], s74 offen offset:128 sc1
    s_mov_b64 exec, s[16:17]
    s_cbranch_execz L_ld_again
    buffer_load_dwordx4 v[116:119], v12, s[28:31], s74 offen offset:192 sc1
    s_mov_b64 exec, s[20:21]
    s_cbranch_execz L_ld_again
    buffer_load_dwordx4 v[120:123], v12, s[28:31], s74 offen offset:256 sc1
L_ld_again:
    s_mov_b64 exec, -1
    s_sub_u32 s87, s87, 1
    s_cbranch_scc0 L_chk
L_chk_ok:
    s_mov_b64 exec, s[4:5]
    v_and_b32 v34, 0x3ff, v104
    v_and_b32 v105, 0xffff0000, v105
    ds_add_rtn_u32 v24, v34, v15 offset:1024
    s_mov_b64 exec, s[6:7]
    v_and_b32 v35, 0x3ff, v106
    v_and_b32 v107, 0xffff0000, v107
    ds_add_rtn_u32 v25, v35, v15 offset:1024
    s_mov_b64 exec, s[8:9]
    v_and_b32 v36, 0x3ff, v108
    v_and_b32 v109, 0xffff0000, v109
    ds_add_rtn_u32 v26, v36, v15 offset:1024
    s_mov_b64 exec, s[10:11]
    s_cbranch_execz L_cnt_done
    v_and_b32 v37, 0x3ff, v110
    v_and_b32 v111, 0xffff0000, v111
    ds_add_rtn_u32 v27, v37, v15 offset:1024
    s_mov_b64 exec, s[12:13]
    s_cbranch_execz L_cnt_done
    v_and_b32 v38, 0x3ff, v112
    v_and_b32 v113, 0xffff0000, v113
    ds_add_rtn_u32 v28, v38, v15 offset:1024
    s_mov_b64 exec, s[14:15]
    s_cbranch_execz L_cnt_done
    v_and_b32 v39, 0x3ff, v114
    v_and_b32 v115, 0xffff0000, v115
    ds_add_rtn_u32 v29, v39, v15 offset:1024
    s_mov_b64 exec, s[16:17]
    s_cbranch_execz L_cnt_done
    v_and_b32 v40, 0x3ff, v116
    v_and_b32 v117, 0xffff0000, v117
    ds_add_rtn_u32 v30, v40, v15 offset:1024
    s_mov_b64 exec, s[18:19]
    s_cbranch_execz L_cnt_done
    v_and_b32 v41, 0x3ff, v118
    v_and_b32 v119, 0xffff0000, v119
    ds_add_rtn_u32 v31, v41, v15 offset:1024
    s_mov_b64 exec, s[20:21]
    s_cbranch_execz L_cnt_done
    v_and_b32 v42, 0x3ff, v120
    v_and_b32 v121, 0xffff0000, v121
    ds_add_rtn_u32 v32, v42, v15 offset:1024
    s_mov_b64 exec, s[22:23]
    s_cbranch_execz L_cnt_done
    v_and_b32 v43, 0x3ff, v122
    v_and_b32 v123, 0xffff0000, v123
    ds_add_rtn_u32 v33, v43, v15 offset:1024
L_cnt_done:
    s_setprio 0
    s_mov_b64 exec, -1
    s_waitcnt lgkmcnt(0)
    s_barrier
    s_cmp_eq_u32 s64, 15
    s_cbranch_scc0 L_nosort
    s_setprio 3
    v_lshlrev_b32 v8, 2, v2
    ds_read_b32 v48, v8 offset:1024
    ds_read_b32 v49, v8 offset:1280
    ds_read_b32 v50, v8 offset:1536
    ds_read_b32 v51, v8 offset:1792
    s_lshl_b32 s75, s67, 7
    s_add_u32 s75, s75, s78
    s_lshl_b32 s75, s75, 3
    s_add_u32 s75, s75, 16322560
    v_mov_b32 v6, s3
    v_mov_b32 v7, s86
    s_mov_b64 exec, 1
    buffer_store_dwordx2 v[6:7], v13, s[28:31], s75 offen sc1
    s_mov_b64 exec, -1
    s_lshl_b32 s75, s67, 7
    s_add_u32 s75, s75, s78
    s_lshl_b32 s75, s75, 3
    s_add_u32 s75, s75, 16323584
    v_mov_b32 v6, s3
    v_mov_b32 v7, s86
    s_mov_b64 exec, 1
    buffer_store_dwordx2 v[6:7], v13, s[28:31], s75 offen sc1
    s_mov_b64 exec, -1
    s_waitcnt lgkmcnt(0)
    v_min_u32 v52, 63, v48
    v_sub_u32 v52, 63, v52
    v_lshlrev_b32 v52, 2, v52
    ds_add_rtn_u32 v56, v52, v15 offset:2048
    v_min_u32 v53, 63, v49
    v_sub_u32 v53, 63, v53
    v_lshlrev_b32 v53, 2, v53
    ds_add_rtn_u32 v57, v53, v15 offset:2048
    v_min_u32 v54, 63, v50
    v_sub_u32 v54, 63, v54
    v_lshlrev_b32 v54, 2, v54
    ds_add_rtn_u32 v58, v54, v15 offset:2048
    v_min_u32 v55, 63, v51
    v_sub_u32 v55, 63, v55
    v_lshlrev_b32 v55, 2, v55
    s_mov_b64 exec, 0xff
    ds_add_rtn_u32 v59, v55, v15 offset:2048
    s_mov_b64 exec, -1
    ds_read_b32 v6, v8 offset:2048
    v_max3_u32 v3, v48, v49, v50
    v_max_u32 v3, v3, v51
    v_cmp_lt_u32 vcc, 63, v3
    s_cmp_lg_u64 vcc, 0
    s_cselect_b32 s76, 1, 0
    v_lshrrev_b32 v10, 1, v2
    v_sub_u32 v11, 31, v10
    v_and_b32 v7, 1, v2
    v_cmp_eq_u32 vcc, 1, v7
    v_add_u32 v12, 192, v2
    v_mov_b32 v7, 0xffff
    v_cndmask_b32 v10, v10, v11, vcc
    v_and_b32 v11, 32, v2
    v_add_u32 v10, v10, v11
    v_cmp_gt_u32 vcc, 4, v2
    v_cmp_gt_u32 s[70:71], 25, v10
    v_lshlrev_b32 v10, 5, v10
    v_cndmask_b32 v12, v7, v12, vcc
    s_waitcnt lgkmcnt(0)
    v_mov_b32 v14, v6
    s_nop 1
    v_add_u32_dpp v14, v14, v14 row_shr:1 row_mask:0xf bank_mask:0xf bound_ctrl:0
    s_nop 1
    v_add_u32_dpp v14, v14, v14 row_shr:2 row_mask:0xf bank_mask:0xf bound_ctrl:0
    s_nop 1
    v_add_u32_dpp v14, v14, v14 row_shr:4 row_mask:0xf bank_mask:0xf bound_ctrl:0
    s_nop 1
    v_add_u32_dpp v14, v14, v14 row_shr:8 row_mask:0xf bank_mask:0xf bound_ctrl:0
    s_nop 1
    v_add_u32_dpp v14, v14, v14 row_bcast:15 row_mask:0xa bank_mask:0xf
    s_nop 1
    v_add_u32_dpp v14, v14, v14 row_bcast:31 row_mask:0xc bank_mask:0xf
    v_sub_u32 v14, v14, v6
    ds_bpermute_b32 v60, v52, v14
    ds_bpermute_b32 v61, v53, v14
    ds_bpermute_b32 v62, v54, v14
    ds_bpermute_b32 v63, v55, v14
    v_lshl_or_b32 v52, v48, 16, v2
    v_add_u32 v3, 64, v2
    v_lshl_or_b32 v53, v49, 16, v3
    v_add_u32 v3, 128, v2
    v_lshl_or_b32 v54, v50, 16, v3
    v_lshl_or_b32 v55, v51, 16, v12
    s_waitcnt lgkmcnt(0)
    v_add_u32 v60, v60, v56
    v_lshlrev_b32 v3, 2, v60
    ds_write_b32 v3, v52 offset:3712
    v_add_u32 v61, v61, v57
    v_lshlrev_b32 v3, 2, v61
    ds_write_b32 v3, v53 offset:3712
    v_add_u32 v62, v62, v58
    v_lshlrev_b32 v3, 2, v62
    ds_write_b32 v3, v54 offset:3712
    v_add_u32 v63, v63, v59
    v_lshlrev_b32 v3, 2, v63
    s_mov_b64 exec, 0xff
    ds_write_b32 v3, v55 offset:3712
    s_mov_b64 exec, -1
    ds_read_u16 v84, v10 offset:3714
    v_lshrrev_b32 v3, 3, v60
    v_sub_u32 v6, 31, v3
    v_cmp_gt_u32 vcc, 16, v3
    v_lshl_or_b32 v6, v6, 3, 4
    v_lshlrev_b32 v3, 3, v3
    v_cndmask_b32 v52, v6, v3, vcc
    v_and_b32 v60, 7, v60
    v_lshlrev_b32 v60, 3, v60
    v_add_u32 v60, 85888, v60
    v_lshrrev_b32 v3, 3, v61
    v_sub_u32 v6, 31, v3
    v_cmp_gt_u32 vcc, 16, v3
    v_lshl_or_b32 v6, v6, 3, 4
    v_lshlrev_b32 v3, 3, v3
    v_cndmask_b32 v53, v6, v3, vcc
    v_and_b32 v61, 7, v61
    v_lshlrev_b32 v61, 3, v61
    v_add_u32 v61, 85888, v61
    v_lshrrev_b32 v3, 3, v62
    v_sub_u32 v6, 31, v3
    v_cmp_gt_u32 vcc, 16, v3
    v_lshl_or_b32 v6, v6, 3, 4
    v_lshlrev_b32 v3, 3, v3
    v_cndmask_b32 v54, v6, v3, vcc
    v_and_b32 v62, 7, v62
    v_lshlrev_b32 v62, 3, v62
    v_add_u32 v62, 85888, v62
    v_lshrrev_b32 v3, 3, v63
    v_sub_u32 v6, 31, v3
    v_cmp_gt_u32 vcc, 16, v3
    v_lshl_or_b32 v6, v6, 3, 4
    v_lshlrev_b32 v3, 3, v3
    v_cndmask_b32 v55, v6, v3, vcc
    v_and_b32 v63, 7, v63
    v_lshlrev_b32 v63, 3, v63
    v_add_u32 v63, 85888, v63
    s_waitcnt lgkmcnt(0)
    v_cndmask_b32 v84, 0, v84, s[70:71]
    v_mov_b32 v85, v84
    s_nop 1
    v_add_u32_dpp v85, v85, v85 row_shr:1 row_mask:0xf bank_mask:0xf bound_ctrl:0
    s_nop 1
    v_add_u32_dpp v85, v85, v85 row_shr:2 row_mask:0xf bank_mask:0xf bound_ctrl:0
    s_nop 1
    v_add_u32_dpp v85, v85, v85 row_shr:4 row_mask:0xf bank_mask:0xf bound_ctrl:0
    s_nop 1
    v_add_u32_dpp v85, v85, v85 row_shr:8 row_mask:0xf bank_mask:0xf bound_ctrl:0
    s_nop 1
    v_add_u32_dpp v85, v85, v85 row_bcast:15 row_mask:0xa bank_mask:0xf
    s_nop 1
    v_add_u32_dpp v85, v85, v85 row_bcast:31 row_mask:0xc bank_mask:0xf
    s_nop 0
    v_readlane_b32 s74, v85, 63
    v_sub_u32 v85, v85, v84
    v_lshl_or_b32 v85, v85, 8, v84
    s_cmp_gt_u32 s74, 512
    s_cselect_b32 s76, 1, s76
    s_cmp_lg_u32 s76, 0
    s_cbranch_scc0 L_fit
    ds_write_b32 v13, v15 offset:2304
    s_branch L_sorted
L_fit:
    ds_bpermute_b32 v56, v52, v85
    ds_bpermute_b32 v57, v53, v85
    ds_bpermute_b32 v58, v54, v85
    ds_bpermute_b32 v59, v55, v85
    ds_write_b32 v8, v85 offset:3456
    s_waitcnt lgkmcnt(1)
    v_lshrrev_b32 v3, 8, v56
    v_lshl_add_u32 v60, v3, 6, v60
    v_lshl_or_b32 v60, v56, 24, v60
    ds_write_b32 v8, v60 offset:2432
    v_lshrrev_b32 v3, 8, v57
    v_lshl_add_u32 v61, v3, 6, v61
    v_lshl_or_b32 v61, v57, 24, v61
    ds_write_b32 v8, v61 offset:2688
    v_lshrrev_b32 v3, 8, v58
    v_lshl_add_u32 v62, v3, 6, v62
    v_lshl_or_b32 v62, v58, 24, v62
    ds_write_b32 v8, v62 offset:2944
    v_lshrrev_b32 v3, 8, v59
    v_lshl_add_u32 v63, v3, 6, v63
    v_lshl_or_b32 v63, v59, 24, v63
    ds_write_b32 v8, v63 offset:3200
    s_branch L_sorted
L_nosort:
    s_cmp_eq_u32 s64, 14
    s_cbranch_scc0 L_nopf
    v_lshlrev_b32 v3, 7, v2
    s_lshl_b32 s75, s79, 7
    buffer_load_dword v48, v3, s[52:55], s75 offen sc1
    s_add_u32 s75, s75, 8192
    buffer_load_dword v49, v3, s[52:55], s75 offen sc1
    s_add_u32 s75, s75, 8192
    buffer_load_dword v50, v3, s[52:55], s75 offen sc1
    s_add_u32 s75, s75, 8192
    s_mov_b64 exec, 0xf
    buffer_load_dword v51, v3, s[52:55], s75 offen sc1
    s_mov_b64 exec, -1
L_nopf:
L_sorted:
    s_setprio 0
    v_lshlrev_b32 v72, 4, v1
    v_mul_u32_u24 v76, 24, v1
    v_lshlrev_b32 v86, 16, v124
    v_lshlrev_b32 v87, 16, v125
    v_and_b32 v88, 0xffff0000, v124
    v_and_b32 v89, 0xffff0000, v125
    v_pk_mul_f32 v[86:87], v[86:87], s[68:69] op_sel_hi:[1,0]
    v_pk_mul_f32 v[88:89], v[88:89], s[68:69] op_sel_hi:[1,0]
    v_lshlrev_b32 v124, 16, v126
    v_lshlrev_b32 v125, 16, v127
    v_and_b32 v126, 0xffff0000, v126
    v_and_b32 v127, 0xffff0000, v127
    v_pk_mul_f32 v[124:125], v[124:125], s[68:69] op_sel_hi:[1,0]
    v_pk_mul_f32 v[126:127], v[126:127], s[68:69] op_sel_hi:[1,0]
    v_add_u32 v76, 5888, v76
    s_lshl_b32 s74, s79, 8
    s_lshl_b32 s75, s67, 6
    s_add_u32 s74, s74, s75
    v_lshl_add_u32 v74, v1, 3, s74
    v_lshlrev_b32 v8, 2, v2
    v_lshrrev_b32 v3, 3, v2
    v_lshlrev_b32 v6, 2, v3
    v_lshlrev_b32 v5, 3, v3
    s_lshl_b32 s74, s64, 5
    v_add_u32 v14, s74, v6
    s_sub_u32 s75, 992, s74
    v_add_u32 v12, s75, v6
    s_xor_b32 s74, s74, 416
    v_add_u32 v4, s74, v6
    s_sub_u32 s75, 992, s74
    v_add_u32 v3, s75, v6
    s_waitcnt lgkmcnt(0)
    s_barrier
    ds_read_b64 v[6:7], v13 offset:2304
    ds_read_b32 v85, v8 offset:3456
    ds_read_b32 v80, v9 offset:2432
    ds_read_b32 v81, v9 offset:1024
    s_mov_b64 exec, s[4:5]
    ds_read_b32 v34, v34 offset:2432
    s_mov_b64 exec, s[6:7]
    ds_read_b32 v35, v35 offset:2432
    s_mov_b64 exec, s[8:9]
    ds_read_b32 v36, v36 offset:2432
    s_mov_b64 exec, s[10:11]
    s_cbranch_execz L_s8a_done
    ds_read_b32 v37, v37 offset:2432
    s_mov_b64 exec, s[12:13]
    s_cbranch_execz L_s8a_done
    ds_read_b32 v38, v38 offset:2432
    s_mov_b64 exec, s[14:15]
    s_cbranch_execz L_s8a_done
    ds_read_b32 v39, v39 offset:2432
    s_mov_b64 exec, s[16:17]
    s_cbranch_execz L_s8a_done
    ds_read_b32 v40, v40 offset:2432
    s_mov_b64 exec, s[18:19]
    s_cbranch_execz L_s8a_done
    ds_read_b32 v41, v41 offset:2432
    s_mov_b64 exec, s[20:21]
    s_cbranch_execz L_s8a_done
    ds_read_b32 v42, v42 offset:2432
    s_mov_b64 exec, s[22:23]
    s_cbranch_execz L_s8a_done
    ds_read_b32 v43, v43 offset:2432
L_s8a_done:
    s_mov_b64 exec, -1
    ds_read_u16 v100, v14 offset:3712
    ds_read_u16 v10, v12 offset:3712
    ds_read_u16 v101, v4 offset:3712
    ds_read_u16 v11, v3 offset:3712
    s_waitcnt lgkmcnt(0)
    v_readfirstlane_b32 s75, v6
    v_readfirstlane_b32 s85, v7
    s_lshl_b32 s74, s64, 1
    v_readlane_b32 s76, v85, s74
    s_or_b32 s75, s75, s85
    s_cbranch_scc1 L_slow
    s_mov_b64 exec, s[4:5]
    v_lshl_add_u32 v34, v24, 6, v34
    v_and_b32 v34, 0xffffff, v34
    ds_write_b64 v34, v[104:105]
    s_mov_b64 exec, s[6:7]
    v_lshl_add_u32 v35, v25, 6, v35
    v_and_b32 v35, 0xffffff, v35
    ds_write_b64 v35, v[106:107]
    s_mov_b64 exec, s[8:9]
    v_lshl_add_u32 v36, v26, 6, v36
    v_and_b32 v36, 0xffffff, v36
    ds_write_b64 v36, v[108:109]
    s_mov_b64 exec, s[10:11]
    s_cbranch_execz L_s8b_done
    v_lshl_add_u32 v37, v27, 6, v37
    v_and_b32 v37, 0xffffff, v37
    ds_write_b64 v37, v[110:111]
    s_mov_b64 exec, s[12:13]
    s_cbranch_execz L_s8b_done
    v_lshl_add_u32 v38, v28, 6, v38
    v_and_b32 v38, 0xffffff, v38
    ds_write_b64 v38, v[112:113]
    s_mov_b64 exec, s[14:15]
    s_cbranch_execz L_s8b_done
    v_lshl_add_u32 v39, v29, 6, v39
    v_and_b32 v39, 0xffffff, v39
    ds_write_b64 v39, v[114:115]
    s_mov_b64 exec, s[16:17]
    s_cbranch_execz L_s8b_done
    v_lshl_add_u32 v40, v30, 6, v40
    v_and_b32 v40, 0xffffff, v40
    ds_write_b64 v40, v[116:117]
    s_mov_b64 exec, s[18:19]
    s_cbranch_execz L_s8b_done
    v_lshl_add_u32 v41, v31, 6, v41
    v_and_b32 v41, 0xffffff, v41
    ds_write_b64 v41, v[118:119]
    s_mov_b64 exec, s[20:21]
    s_cbranch_execz L_s8b_done
    v_lshl_add_u32 v42, v32, 6, v42
    v_and_b32 v42, 0xffffff, v42
    ds_write_b64 v42, v[120:121]
    s_mov_b64 exec, s[22:23]
    s_cbranch_execz L_s8b_done
    v_lshl_add_u32 v43, v33, 6, v43
    v_and_b32 v43, 0xffffff, v43
    ds_write_b64 v43, v[122:123]
L_s8b_done:
    s_mov_b64 exec, -1
    s_cmp_lt_u32 s64, 4
    s_cbranch_scc0 L_pad_done
    v_lshrrev_b32 v82, 24, v80
    v_lshl_add_u32 v80, v81, 6, v80
    v_and_b32 v80, 0xffffff, v80
    v_mov_b32 v6, 1644167168
    v_mov_b32 v7, 0
    s_movk_i32 s75, 200
    v_cmpx_gt_u32 vcc, s75, v0
L_pad:
    v_cmpx_gt_u32 vcc, v82, v81
    s_cbranch_execz L_pad_done
    ds_write_b64 v80, v[6:7]
    v_add_u32 v80, 64, v80
    v_add_u32 v81, 1, v81
    s_branch L_pad
L_pad_done:
    s_mov_b64 exec, -1
    s_add_u32 s74, s74, 1
    v_readlane_b32 s81, v85, s74
    s_xor_b32 s74, s74, 26
    v_readlane_b32 s83, v85, s74
    s_sub_u32 s74, s74, 1
    v_readlane_b32 s89, v85, s74
    s_and_b32 s80, s76, 0xff
    s_lshr_b32 s76, s76, 8
    s_and_b32 s81, s81, 0xff
    s_and_b32 s83, s83, 0xff
    s_and_b32 s82, s89, 0xff
    s_lshr_b32 s89, s89, 8
    s_lshl_b32 s76, s76, 6
    s_add_u32 s76, s76, 85888
    s_lshl_b32 s89, s89, 6
    s_add_u32 s89, s89, 85888
    v_add_u32 v73, s76, v5
    s_cmp_eq_u32 s64, 14
    s_cbranch_scc0 L_nopoll2
    v_lshlrev_b32 v3, 4, v2
    s_lshl_b32 s76, s67, 10
    s_add_u32 s76, s76, 16322560
    s_mov_b32 s87, 65536
L_pb:
    buffer_load_dwordx4 v[48:51], v3, s[28:31], s76 offen sc1
    s_waitcnt vmcnt(0)
    v_xor_b32 v48, s3, v48
    v_xor_b32 v49, s86, v49
    v_xor_b32 v50, s3, v50
    v_xor_b32 v51, s86, v51
    v_or3_b32 v48, v48, v49, v50
    v_or_b32 v48, v48, v51
    v_cmp_ne_u32 vcc, 0, v48
    s_cbranch_vccz L_pb_ok
    s_sleep 2
    s_sub_u32 s87, s87, 1
    s_cbranch_scc0 L_pb
L_pb_ok:
L_nopoll2:
    s_cmp_ge_u32 s64, 7
    s_cselect_b32 s84, 2, 1
    s_mov_b32 s88, 0
    s_movk_i32 s77, 128
    s_waitcnt lgkmcnt(0)
    v_lshl_or_b32 v100, v10, 16, v100
    v_lshl_or_b32 v101, v11, 16, v101
    s_barrier
    s_movk_i32 s74, 200
    s_movk_i32 s75, 256
    s_setprio 3
M_prime:
    ds_read_b64 v[104:105], v73 offset:0
    ds_read_b64 v[106:107], v73 offset:64
    ds_read_b64 v[108:109], v73 offset:128
    ds_read_b64 v[110:111], v73 offset:192
    s_waitcnt lgkmcnt(3)
    v_mad_u32_u16 v104, v104, s77, v72 op_sel:[1,0,0,0]
    buffer_load_dwordx4 v[16:19], v104, s[52:55], s88 offen sc1
    s_waitcnt lgkmcnt(2)
    v_mad_u32_u16 v106, v106, s77, v72 op_sel:[1,0,0,0]
    buffer_load_dwordx4 v[20:23], v106, s[52:55], s88 offen sc1
    s_waitcnt lgkmcnt(1)
    v_mad_u32_u16 v108, v108, s77, v72 op_sel:[1,0,0,0]
    buffer_load_dwordx4 v[24:27], v108, s[52:55], s88 offen sc1
    s_waitcnt lgkmcnt(0)
    v_mad_u32_u16 v110, v110, s77, v72 op_sel:[1,0,0,0]
    buffer_load_dwordx4 v[28:31], v110, s[52:55], s88 offen sc1
    v_mad_u32_u16 v3, v100, s74, v76
    v_mad_u32_u16 v75, v100, s75, v74
    ds_read2_b64 v[78:81], v3 offset0:0 offset1:1
    ds_read_b64 v[82:83], v3 offset:16
    v_lshrrev_b32 v100, 16, v100
    v_mov_b64 v[92:93], 0
    v_mov_b64 v[94:95], 0
    v_mov_b64 v[96:97], 0
    v_mov_b64 v[98:99], 0
    s_waitcnt lgkmcnt(0)
    v_lshlrev_b32 v90, 16, v78
    v_lshlrev_b32 v91, 16, v79
    v_and_b32 v78, 0xffff0000, v78
    v_and_b32 v79, 0xffff0000, v79
    s_sub_u32 s80, s80, 1
    s_cbranch_scc1 M_sw3
M_loop:
M_it0:
    s_waitcnt vmcnt(3)
    v_lshlrev_b64 v[64:65], 16, v[16:17]
    v_pk_fma_f32 v[66:67], v[104:105], v[88:89], v[16:17] op_sel:[1,0,0] op_sel_hi:[1,1,1]
    v_pk_fma_f32 v[64:65], v[104:105], v[86:87], v[64:65] op_sel:[1,0,0] op_sel_hi:[1,1,1]
    ds_read_b64 v[104:105], v73 offset:256
    v_exp_f32 v66, v66
    v_exp_f32 v67, v67
    v_exp_f32 v64, v64
    v_exp_f32 v65, v65
    v_lshlrev_b64 v[68:69], 16, v[18:19]
    v_pk_add_f32 v[66:67], v[66:67], v[78:79]
    v_pk_add_f32 v[64:65], v[64:65], v[90:91]
    v_rcp_f32 v66, v66
    v_rcp_f32 v67, v67
    v_rcp_f32 v64, v64
    v_rcp_f32 v65, v65
    v_pk_add_f32 v[94:95], v[94:95], v[66:67]
    v_pk_fma_f32 v[98:99], v[66:67], v[18:19], v[98:99]
    v_pk_add_f32 v[92:93], v[92:93], v[64:65]
    v_pk_fma_f32 v[96:97], v[64:65], v[68:69], v[96:97]
    s_waitcnt lgkmcnt(0)
    v_mad_u32_u16 v104, v104, s77, v72 op_sel:[1,0,0,0]
    s_sub_u32 s80, s80, 1
    buffer_load_dwordx4 v[16:19], v104, s[52:55], s88 offen sc1
    s_cbranch_scc1 M_sw0
M_it1:
    s_waitcnt vmcnt(3)
    v_lshlrev_b64 v[64:65], 16, v[20:21]
    v_pk_fma_f32 v[66:67], v[106:107], v[88:89], v[20:21] op_sel:[1,0,0] op_sel_hi:[1,1,1]
    v_pk_fma_f32 v[64:65], v[106:107], v[86:87], v[64:65] op_sel:[1,0,0] op_sel_hi:[1,1,1]
    ds_read_b64 v[106:107], v73 offset:320
    v_exp_f32 v66, v66
    v_exp_f32 v67, v67
    v_exp_f32 v64, v64
    v_exp_f32 v65, v65
    v_lshlrev_b64 v[68:69], 16, v[22:23]
    v_pk_add_f32 v[66:67], v[66:67], v[78:79]
    v_pk_add_f32 v[64:65], v[64:65], v[90:91]
    v_rcp_f32 v66, v66
    v_rcp_f32 v67, v67
    v_rcp_f32 v64, v64
    v_rcp_f32 v65, v65
    v_pk_add_f32 v[94:95], v[94:95], v[66:67]
    v_pk_fma_f32 v[98:99], v[66:67], v[22:23], v[98:99]
    v_pk_add_f32 v[92:93], v[92:93], v[64:65]
    v_pk_fma_f32 v[96:97], v[64:65], v[68:69], v[96:97]
    s_waitcnt lgkmcnt(0)
    v_mad_u32_u16 v106, v106, s77, v72 op_sel:[1,0,0,0]
    s_sub_u32 s80, s80, 1
    buffer_load_dwordx4 v[20:23], v106, s[52:55], s88 offen sc1
    s_cbranch_scc1 M_sw1
M_it2:
    s_waitcnt vmcnt(3)
    v_lshlrev_b64 v[64:65], 16, v[24:25]
    v_pk_fma_f32 v[66:67], v[108:109], v[88:89], v[24:25] op_sel:[1,0,0] op_sel_hi:[1,1,1]
    v_pk_fma_f32 v[64:65], v[108:109], v[86:87], v[64:65] op_sel:[1,0,0] op_sel_hi:[1,1,1]
    ds_read_b64 v[108:109], v73 offset:384
    v_exp_f32 v66, v66
    v_exp_f32 v67, v67
    v_exp_f32 v64, v64
    v_exp_f32 v65, v65
    v_lshlrev_b64 v[68:69], 16, v[26:27]
    v_pk_add_f32 v[66:67], v[66:67], v[78:79]
    v_pk_add_f32 v[64:65], v[64:65], v[90:91]
    v_rcp_f32 v66, v66
    v_rcp_f32 v67, v67
    v_rcp_f32 v64, v64
    v_rcp_f32 v65, v65
    v_pk_add_f32 v[94:95], v[94:95], v[66:67]
    v_pk_fma_f32 v[98:99], v[66:67], v[26:27], v[98:99]
    v_pk_add_f32 v[92:93], v[92:93], v[64:65]
    v_pk_fma_f32 v[96:97], v[64:65], v[68:69], v[96:97]
    s_waitcnt lgkmcnt(0)
    v_mad_u32_u16 v108, v108, s77, v72 op_sel:[1,0,0,0]
    s_sub_u32 s80, s80, 1
    buffer_load_dwordx4 v[24:27], v108, s[52:55], s88 offen sc1
    s_cbranch_scc1 M_sw2
M_it3:
    s_waitcnt vmcnt(3)
    v_lshlrev_b64 v[64:65], 16, v[28:29]
    v_pk_fma_f32 v[66:67], v[110:111], v[88:89], v[28:29] op_sel:[1,0,0] op_sel_hi:[1,1,1]
    v_pk_fma_f32 v[64:65], v[110:111], v[86:87], v[64:65] op_sel:[1,0,0] op_sel_hi:[1,1,1]
    ds_read_b64 v[110:111], v73 offset:448
    v_exp_f32 v66, v66
    v_exp_f32 v67, v67
    v_exp_f32 v64, v64
    v_exp_f32 v65, v65
    v_lshlrev_b64 v[68:69], 16, v[30:31]
    v_pk_add_f32 v[66:67], v[66:67], v[78:79]
    v_pk_add_f32 v[64:65], v[64:65], v[90:91]
    v_add_u32 v73, 256, v73
    v_rcp_f32 v66, v66
    v_rcp_f32 v67, v67
    v_rcp_f32 v64, v64
    v_rcp_f32 v65, v65
    v_pk_add_f32 v[94:95], v[94:95], v[66:67]
    v_pk_fma_f32 v[98:99], v[66:67], v[30:31], v[98:99]
    v_pk_add_f32 v[92:93], v[92:93], v[64:65]
    v_pk_fma_f32 v[96:97], v[64:65], v[68:69], v[96:97]
    s_waitcnt lgkmcnt(0)
    v_mad_u32_u16 v110, v110, s77, v72 op_sel:[1,0,0,0]
    s_sub_u32 s80, s80, 1
    buffer_load_dwordx4 v[28:31], v110, s[52:55], s88 offen sc1
    s_cbranch_scc1 M_sw3
    s_branch M_loop
M_sw0:
    v_pk_fma_f32 v[92:93], v[92:93], v[90:91], s[72:73]
    v_pk_fma_f32 v[94:95], v[94:95], v[78:79], s[72:73]
    v_pk_mul_f32 v[96:97], v[96:97], v[90:91]
    v_pk_mul_f32 v[98:99], v[98:99], v[78:79]
    v_lshlrev_b32 v64, 16, v80
    v_lshlrev_b32 v65, 16, v81
    v_and_b32 v66, 0xffff0000, v80
    v_and_b32 v67, 0xffff0000, v81
    v_rcp_f32 v92, v92
    v_rcp_f32 v93, v93
    v_rcp_f32 v94, v94
    v_rcp_f32 v95, v95
    v_lshlrev_b32 v68, 16, v82
    v_lshlrev_b32 v69, 16, v83
    v_pk_fma_f32 v[64:65], v[96:97], v[92:93], v[64:65]
    v_pk_fma_f32 v[66:67], v[98:99], v[94:95], v[66:67]
    v_and_b32 v70, 0xffff0000, v82
    v_and_b32 v71, 0xffff0000, v83
    v_max_f32 v64, 0, v64
    v_max_f32 v65, 0, v65
    v_max_f32 v66, 0, v66
    v_max_f32 v67, 0, v67
    v_pk_add_f32 v[64:65], v[64:65], v[68:69]
    v_pk_add_f32 v[66:67], v[66:67], v[70:71]
    v_cvt_pk_bf16_f32 v68, v64, v66
    v_cvt_pk_bf16_f32 v69, v65, v67
    buffer_store_dwordx2 v[68:69], v75, s[56:59], 0 offen sc1
    s_sub_u32 s84, s84, 1
    s_cmp_eq_u32 s84, 0
    s_cbranch_scc1 M_phase
    s_cmp_eq_u32 s88, 0
    s_cbranch_scc1 M_p0
    s_setprio 0
    s_branch M_q0
M_p0:
    s_setprio 2
M_q0:
    v_mad_u32_u16 v3, v100, s74, v76
    v_mad_u32_u16 v75, v100, s75, v74
    ds_read2_b64 v[78:81], v3 offset0:0 offset1:1
    ds_read_b64 v[82:83], v3 offset:16
    v_lshrrev_b32 v100, 16, v100
    v_mov_b64 v[92:93], 0
    v_mov_b64 v[94:95], 0
    v_mov_b64 v[96:97], 0
    v_mov_b64 v[98:99], 0
    s_waitcnt lgkmcnt(0)
    v_lshlrev_b32 v90, 16, v78
    v_lshlrev_b32 v91, 16, v79
    v_and_b32 v78, 0xffff0000, v78
    v_and_b32 v79, 0xffff0000, v79
    s_sub_u32 s80, s81, 1
    s_cbranch_scc1 M_sw0
    s_branch M_it1
M_sw1:
    v_pk_fma_f32 v[92:93], v[92:93], v[90:91], s[72:73]
    v_pk_fma_f32 v[94:95], v[94:95], v[78:79], s[72:73]
    v_pk_mul_f32 v[96:97], v[96:97], v[90:91]
    v_pk_mul_f32 v[98:99], v[98:99], v[78:79]
    v_lshlrev_b32 v64, 16, v80
    v_lshlrev_b32 v65, 16, v81
    v_and_b32 v66, 0xffff0000, v80
    v_and_b32 v67, 0xffff0000, v81
    v_rcp_f32 v92, v92
    v_rcp_f32 v93, v93
    v_rcp_f32 v94, v94
    v_rcp_f32 v95, v95
    v_lshlrev_b32 v68, 16, v82
    v_lshlrev_b32 v69, 16, v83
    v_pk_fma_f32 v[64:65], v[96:97], v[92:93], v[64:65]
    v_pk_fma_f32 v[66:67], v[98:99], v[94:95], v[66:67]
    v_and_b32 v70, 0xffff0000, v82
    v_and_b32 v71, 0xffff0000, v83
    v_max_f32 v64, 0, v64
    v_max_f32 v65, 0, v65
    v_max_f32 v66, 0, v66
    v_max_f32 v67, 0, v67
    v_pk_add_f32 v[64:65], v[64:65], v[68:69]
    v_pk_add_f32 v[66:67], v[66:67], v[70:71]
    v_cvt_pk_bf16_f32 v68, v64, v66
    v_cvt_pk_bf16_f32 v69, v65, v67
    buffer_store_dwordx2 v[68:69], v75, s[56:59], 0 offen sc1
    s_sub_u32 s84, s84, 1
    s_cmp_eq_u32 s84, 0
    s_cbranch_scc1 M_phase
    s_cmp_eq_u32 s88, 0
    s_cbranch_scc1 M_p1
    s_setprio 0
    s_branch M_q1
M_p1:
    s_setprio 2
M_q1:
    v_mad_u32_u16 v3, v100, s74, v76
    v_mad_u32_u16 v75, v100, s75, v74
    ds_read2_b64 v[78:81], v3 offset0:0 offset1:1
    ds_read_b64 v[82:83], v3 offset:16
    v_lshrrev_b32 v100, 16, v100
    v_mov_b64 v[92:93], 0
    v_mov_b64 v[94:95], 0
    v_mov_b64 v[96:97], 0
    v_mov_b64 v[98:99], 0
    s_waitcnt lgkmcnt(0)
    v_lshlrev_b32 v90, 16, v78
    v_lshlrev_b32 v91, 16, v79
    v_and_b32 v78, 0xffff0000, v78
    v_and_b32 v79, 0xffff0000, v79
    s_sub_u32 s80, s81, 1
    s_cbranch_scc1 M_sw1
    s_branch M_it2
M_sw2:
    v_pk_fma_f32 v[92:93], v[92:93], v[90:91], s[72:73]
    v_pk_fma_f32 v[94:95], v[94:95], v[78:79], s[72:73]
    v_pk_mul_f32 v[96:97], v[96:97], v[90:91]
    v_pk_mul_f32 v[98:99], v[98:99], v[78:79]
    v_lshlrev_b32 v64, 16, v80
    v_lshlrev_b32 v65, 16, v81
    v_and_b32 v66, 0xffff0000, v80
    v_and_b32 v67, 0xffff0000, v81
    v_rcp_f32 v92, v92
    v_rcp_f32 v93, v93
    v_rcp_f32 v94, v94
    v_rcp_f32 v95, v95
    v_lshlrev_b32 v68, 16, v82
    v_lshlrev_b32 v69, 16, v83
    v_pk_fma_f32 v[64:65], v[96:97], v[92:93], v[64:65]
    v_pk_fma_f32 v[66:67], v[98:99], v[94:95], v[66:67]
    v_and_b32 v70, 0xffff0000, v82
    v_and_b32 v71, 0xffff0000, v83
    v_max_f32 v64, 0, v64
    v_max_f32 v65, 0, v65
    v_max_f32 v66, 0, v66
    v_max_f32 v67, 0, v67
    v_pk_add_f32 v[64:65], v[64:65], v[68:69]
    v_pk_add_f32 v[66:67], v[66:67], v[70:71]
    v_cvt_pk_bf16_f32 v68, v64, v66
    v_cvt_pk_bf16_f32 v69, v65, v67
    buffer_store_dwordx2 v[68:69], v75, s[56:59], 0 offen sc1
    s_sub_u32 s84, s84, 1
    s_cmp_eq_u32 s84, 0
    s_cbranch_scc1 M_phase
    s_cmp_eq_u32 s88, 0
    s_cbranch_scc1 M_p2
    s_setprio 0
    s_branch M_q2
M_p2:
    s_setprio 2
M_q2:
    v_mad_u32_u16 v3, v100, s74, v76
    v_mad_u32_u16 v75, v100, s75, v74
    ds_read2_b64 v[78:81], v3 offset0:0 offset1:1
    ds_read_b64 v[82:83], v3 offset:16
    v_lshrrev_b32 v100, 16, v100
    v_mov_b64 v[92:93], 0
    v_mov_b64 v[94:95], 0
    v_mov_b64 v[96:97], 0
    v_mov_b64 v[98:99], 0
    s_waitcnt lgkmcnt(0)
    v_lshlrev_b32 v90, 16, v78
    v_lshlrev_b32 v91, 16, v79
    v_and_b32 v78, 0xffff0000, v78
    v_and_b32 v79, 0xffff0000, v79
    s_sub_u32 s80, s81, 1
    s_cbranch_scc1 M_sw2
    s_branch M_it3
M_sw3:
    v_pk_fma_f32 v[92:93], v[92:93], v[90:91], s[72:73]
    v_pk_fma_f32 v[94:95], v[94:95], v[78:79], s[72:73]
    v_pk_mul_f32 v[96:97], v[96:97], v[90:91]
    v_pk_mul_f32 v[98:99], v[98:99], v[78:79]
    v_lshlrev_b32 v64, 16, v80
    v_lshlrev_b32 v65, 16, v81
    v_and_b32 v66, 0xffff0000, v80
    v_and_b32 v67, 0xffff0000, v81
    v_rcp_f32 v92, v92
    v_rcp_f32 v93, v93
    v_rcp_f32 v94, v94
    v_rcp_f32 v95, v95
    v_lshlrev_b32 v68, 16, v82
    v_lshlrev_b32 v69, 16, v83
    v_pk_fma_f32 v[64:65], v[96:97], v[92:93], v[64:65]
    v_pk_fma_f32 v[66:67], v[98:99], v[94:95], v[66:67]
    v_and_b32 v70, 0xffff0000, v82
    v_and_b32 v71, 0xffff0000, v83
    v_max_f32 v64, 0, v64
    v_max_f32 v65, 0, v65
    v_max_f32 v66, 0, v66
    v_max_f32 v67, 0, v67
    v_pk_add_f32 v[64:65], v[64:65], v[68:69]
    v_pk_add_f32 v[66:67], v[66:67], v[70:71]
    v_cvt_pk_bf16_f32 v68, v64, v66
    v_cvt_pk_bf16_f32 v69, v65, v67
    buffer_store_dwordx2 v[68:69], v75, s[56:59], 0 offen sc1
    s_sub_u32 s84, s84, 1
    s_cmp_eq_u32 s84, 0
    s_cbranch_scc1 M_phase
    s_cmp_eq_u32 s88, 0
    s_cbranch_scc1 M_p3
    s_setprio 0
    s_branch M_q3
M_p3:
    s_setprio 2
M_q3:
    v_mad_u32_u16 v3, v100, s74, v76
    v_mad_u32_u16 v75, v100, s75, v74
    ds_read2_b64 v[78:81], v3 offset0:0 offset1:1
    ds_read_b64 v[82:83], v3 offset:16
    v_lshrrev_b32 v100, 16, v100
    v_mov_b64 v[92:93], 0
    v_mov_b64 v[94:95], 0
    v_mov_b64 v[96:97], 0
    v_mov_b64 v[98:99], 0
    s_waitcnt lgkmcnt(0)
    v_lshlrev_b32 v90, 16, v78
    v_lshlrev_b32 v91, 16, v79
    v_and_b32 v78, 0xffff0000, v78
    v_and_b32 v79, 0xffff0000, v79
    s_sub_u32 s80, s81, 1
    s_cbranch_scc1 M_sw3
    s_branch M_it0
M_phase:
    s_cmp_eq_u32 s88, 0
    s_cbranch_scc0 L_end
    s_setprio 1
    v_lshlrev_b32 v3, 4, v2
    s_lshl_b32 s76, s67, 10
    s_add_u32 s76, s76, 16323584
    s_mov_b32 s87, 65536
L_pd:
    buffer_load_dwordx4 v[64:67], v3, s[28:31], s76 offen sc1
    s_waitcnt vmcnt(0)
    v_xor_b32 v64, s3, v64
    v_xor_b32 v65, s86, v65
    v_xor_b32 v66, s3, v66
    v_xor_b32 v67, s86, v67
    v_or3_b32 v64, v64, v65, v66
    v_or_b32 v64, v64, v67
    v_cmp_ne_u32 vcc, 0, v64
    s_cbranch_vccz L_pd_ok
    s_sleep 2
    s_sub_u32 s87, s87, 1
    s_cbranch_scc0 L_pd
L_pd_ok:
    s_mov_b32 s88, 3212288
    v_mov_b64 v[86:87], v[124:125]
    v_mov_b64 v[88:89], v[126:127]
    v_add_u32 v76, 40000, v76
    v_add_u32 v74, 64, v74
    v_add_u32 v73, s89, v5
    v_mov_b32 v100, v101
    s_mov_b32 s80, s82
    s_mov_b32 s81, s83
    s_xor_b32 s84, s64, 13
    s_cmp_ge_u32 s84, 7
    s_cselect_b32 s84, 2, 1
    s_branch M_prime
L_slow:
    s_xor_b32 s67, s67, 2
    v_lshlrev_b32 v3, 4, v2
    s_lshl_b32 s76, s67, 10
    s_add_u32 s76, s76, 16322560
    s_mov_b32 s87, 65536
S_pc:
    buffer_load_dwordx4 v[24:27], v3, s[28:31], s76 offen sc1
    s_waitcnt vmcnt(0)
    v_xor_b32 v24, s3, v24
    v_xor_b32 v25, s86, v25
    v_xor_b32 v26, s3, v26
    v_xor_b32 v27, s86, v27
    v_or3_b32 v24, v24, v25, v26
    v_or_b32 v24, v24, v27
    v_cmp_ne_u32 vcc, 0, v24
    s_cbranch_vccz S_pc_ok
    s_sleep 2
    s_sub_u32 s87, s87, 1
    s_cbranch_scc0 S_pc
S_pc_ok:
    s_xor_b32 s67, s67, 2
    v_lshlrev_b32 v3, 4, v2
    s_lshl_b32 s76, s67, 10
    s_add_u32 s76, s76, 16322560
    s_mov_b32 s87, 65536
S_pa:
    buffer_load_dwordx4 v[24:27], v3, s[28:31], s76 offen sc1
    s_waitcnt vmcnt(0)
    v_xor_b32 v24, s3, v24
    v_xor_b32 v25, s86, v25
    v_xor_b32 v26, s3, v26
    v_xor_b32 v27, s86, v27
    v_or3_b32 v24, v24, v25, v26
    v_or_b32 v24, v24, v27
    v_cmp_ne_u32 vcc, 0, v24
    s_cbranch_vccz S_pa_ok
    s_sleep 2
    s_sub_u32 s87, s87, 1
    s_cbranch_scc0 S_pa
S_pa_ok:
    v_lshlrev_b32 v3, 4, v2
    s_lshl_b32 s76, s67, 10
    s_add_u32 s76, s76, 16323584
    s_mov_b32 s87, 65536
S_pb:
    buffer_load_dwordx4 v[24:27], v3, s[28:31], s76 offen sc1
    s_waitcnt vmcnt(0)
    v_xor_b32 v24, s3, v24
    v_xor_b32 v25, s86, v25
    v_xor_b32 v26, s3, v26
    v_xor_b32 v27, s86, v27
    v_or3_b32 v24, v24, v25, v26
    v_or_b32 v24, v24, v27
    v_cmp_ne_u32 vcc, 0, v24
    s_cbranch_vccz S_pb_ok
    s_sleep 2
    s_sub_u32 s87, s87, 1
    s_cbranch_scc0 S_pb
S_pb_ok:
    v_lshrrev_b32 v16, 3, v0
    s_mov_b32 s88, 0
    s_movk_i32 s77, 200
    s_movk_i32 s80, 128
    s_mov_b32 s89, 0
S_half:
    s_barrier
    v_mov_b32 v24, 0
    v_mov_b32 v25, 0
    v_mov_b32 v26, 0
    v_mov_b32 v27, 0
    v_lshlrev_b32 v3, 4, v0
    v_add_u32 v3, 85888, v3
    ds_write_b128 v3, v[24:27] offset:0
    ds_write_b128 v3, v[24:27] offset:16384
    ds_write_b128 v3, v[24:27] offset:32768
    s_cmp_lt_u32 s64, 2
    s_cbranch_scc0 S_nofill
    ds_write_b128 v3, v[24:27] offset:49152
S_nofill:
    s_waitcnt lgkmcnt(0)
    s_barrier
    s_mov_b32 s82, 0
S_piece:
    v_add_u32 v3, s82, v16
    v_lshlrev_b32 v5, 2, v3
    ds_read_b32 v4, v5 offset:4864
    s_movk_i32 s74, 12544
    v_mul_u32_u24 v18, s74, v3
    v_mov_b32 v17, 0
    s_waitcnt lgkmcnt(0)
    v_and_b32 v5, 0x7ff, v4
    v_lshrrev_b32 v4, 11, v4
    v_lshl_add_u32 v18, v5, 3, v18
    s_mov_b32 s74, 12849152
S_rec:
    v_cmpx_gt_u32 vcc, v4, v17
    s_cbranch_execz S_rec_done
    buffer_load_dwordx2 v[20:21], v18, s[28:31], s74 offen sc1
    s_waitcnt vmcnt(0)
    v_bfe_u32 v5, v20, 2, 8
    v_and_b32 v21, 0xffff0000, v21
    v_mad_u32_u16 v20, v20, s80, v72 op_sel:[1,0,0,0]
    v_mad_u32_u24 v3, v5, s77, v76
    v_lshlrev_b32 v19, 8, v5
    v_lshl_add_u32 v19, v1, 5, v19
    v_add_u32 v19, 85888, v19
    buffer_load_dwordx4 v[24:27], v20, s[52:55], s89 offen sc1
    ds_read_b64 v[78:79], v3
    s_waitcnt vmcnt(0) lgkmcnt(0)
    v_lshlrev_b64 v[32:33], 16, v[24:25]
    v_lshlrev_b64 v[36:37], 16, v[26:27]
    v_lshlrev_b32 v38, 16, v78
    v_lshlrev_b32 v39, 16, v79
    v_and_b32 v78, 0xffff0000, v78
    v_and_b32 v79, 0xffff0000, v79
    v_lshrrev_b32 v5, 5, v5
    v_lshl_add_u32 v5, v5, 1, s88
    v_lshrrev_b32 v5, v5, s85
    v_and_b32 v5, 1, v5
    v_cmp_eq_u32 vcc, 0, v5
    v_log_f32 v3, v38
    s_nop 0
    v_cndmask_b32 v38, v38, -v3, vcc
    v_log_f32 v3, v39
    s_nop 0
    v_cndmask_b32 v39, v39, -v3, vcc
    v_log_f32 v3, v78
    s_nop 0
    v_cndmask_b32 v78, v78, -v3, vcc
    v_log_f32 v3, v79
    s_nop 0
    v_cndmask_b32 v79, v79, -v3, vcc
    v_pk_add_f32 v[32:33], v[32:33], v[38:39]
    v_pk_add_f32 v[34:35], v[24:25], v[78:79]
    v_pk_fma_f32 v[32:33], v[20:21], v[86:87], v[32:33] op_sel:[1,0,0] op_sel_hi:[1,1,1]
    v_pk_fma_f32 v[34:35], v[20:21], v[88:89], v[34:35] op_sel:[1,0,0] op_sel_hi:[1,1,1]
    v_exp_f32 v32, v32
    v_exp_f32 v33, v33
    v_exp_f32 v34, v34
    v_exp_f32 v35, v35
    s_nop 0
    v_pk_add_f32 v[32:33], v[32:33], 1.0 op_sel_hi:[1,0]
    v_pk_add_f32 v[34:35], v[34:35], 1.0 op_sel_hi:[1,0]
    v_rcp_f32 v32, v32
    v_rcp_f32 v33, v33
    v_rcp_f32 v34, v34
    v_rcp_f32 v35, v35
    s_nop 0
    v_pk_mul_f32 v[36:37], v[36:37], v[32:33]
    v_pk_mul_f32 v[38:39], v[26:27], v[34:35]
    ds_add_f32 v19, v32 offset:0
    ds_add_f32 v19, v33 offset:4
    ds_add_f32 v19, v34 offset:8
    ds_add_f32 v19, v35 offset:12
    ds_add_f32 v19, v36 offset:16
    ds_add_f32 v19, v37 offset:20
    ds_add_f32 v19, v38 offset:24
    ds_add_f32 v19, v39 offset:28
    s_mov_b64 exec, -1
    v_add_u32 v17, 1, v17
    v_add_u32 v18, 8, v18
    s_branch S_rec
S_rec_done:
    s_mov_b64 exec, -1
    s_add_u32 s82, s82, 128
    s_cmp_lt_u32 s82, 256
    s_cbranch_scc1 S_piece
    s_waitcnt lgkmcnt(0)
    s_barrier
    s_mov_b32 s82, 0
    s_movk_i32 s76, 196
S_fin:
    v_add_u32 v5, s82, v16
    v_mad_u32_u24 v3, v5, s77, v76
    v_lshlrev_b32 v19, 8, v5
    v_lshl_add_u32 v19, v1, 5, v19
    v_add_u32 v19, 85888, v19
    v_lshl_add_u32 v75, v5, 8, v74
    v_cmpx_gt_u32 vcc, s76, v5
    s_cbranch_execz S_fin_next
    ds_read2_b64 v[80:83], v3 offset0:1 offset1:2
    ds_read_b128 v[24:27], v19
    ds_read_b128 v[28:31], v19 offset:16
    s_waitcnt lgkmcnt(0)
    v_pk_add_f32 v[24:25], v[24:25], s[72:73]
    v_pk_add_f32 v[26:27], v[26:27], s[72:73]
    v_lshlrev_b32 v64, 16, v80
    v_lshlrev_b32 v65, 16, v81
    v_and_b32 v66, 0xffff0000, v80
    v_and_b32 v67, 0xffff0000, v81
    v_rcp_f32 v24, v24
    v_rcp_f32 v25, v25
    v_rcp_f32 v26, v26
    v_rcp_f32 v27, v27
    v_lshlrev_b32 v68, 16, v82
    v_lshlrev_b32 v69, 16, v83
    v_pk_fma_f32 v[64:65], v[28:29], v[24:25], v[64:65]
    v_pk_fma_f32 v[66:67], v[30:31], v[26:27], v[66:67]
    v_and_b32 v70, 0xffff0000, v82
    v_and_b32 v71, 0xffff0000, v83
    v_max_f32 v64, 0, v64
    v_max_f32 v65, 0, v65
    v_max_f32 v66, 0, v66
    v_max_f32 v67, 0, v67
    v_pk_add_f32 v[64:65], v[64:65], v[68:69]
    v_pk_add_f32 v[66:67], v[66:67], v[70:71]
    v_cvt_pk_bf16_f32 v68, v64, v66
    v_cvt_pk_bf16_f32 v69, v65, v67
    buffer_store_dwordx2 v[68:69], v75, s[56:59], 0 offen sc1
S_fin_next:
    s_mov_b64 exec, -1
    s_add_u32 s82, s82, 128
    s_cmp_lt_u32 s82, 256
    s_cbranch_scc1 S_fin
    v_mov_b64 v[86:87], v[124:125]
    v_mov_b64 v[88:89], v[126:127]
    v_add_u32 v76, 40000, v76
    v_add_u32 v74, 64, v74
    s_mov_b32 s89, 3212288
    s_add_u32 s88, s88, 1
    s_cmp_lt_u32 s88, 2
    s_cbranch_scc1 S_half
L_end:
L_exit:
    s_endpgm
.section .rodata,"a"
.p2align 6
.amdhsa_kernel standalone__edge_featured_mpnn_gatedgcn__graph_kernel
  .amdhsa_next_free_vgpr 128
  .amdhsa_next_free_sgpr 90
  .amdhsa_accum_offset 128
  .amdhsa_group_segment_fixed_size 0
  .amdhsa_kernarg_size 96
  .amdhsa_user_sgpr_count 2
  .amdhsa_user_sgpr_kernarg_segment_ptr 1
  .amdhsa_system_sgpr_workgroup_id_x 1
.end_amdhsa_kernel
```
